```python
import torch

def _softmax(x, axis=-1):
    return torch.softmax(x, dim=axis)
def _gelu(x):
    return torch.nn.functional.gelu(x, approximate="tanh")
def _silu(x):
    return torch.nn.functional.silu(x)
def _sigmoid(x):
    return torch.sigmoid(x)
def _layernorm(x, axis=-1, eps=1e-5):
    m = x.mean(dim=axis, keepdim=True)
    v = x.var(dim=axis, keepdim=True, unbiased=False)
    return (x - m) / torch.sqrt(v + eps)
def _scatter_add(tgt, idx, src, axis=0):
    return tgt.clone().index_add_(axis, idx, src)
def _segment_sum(src, seg, n):
    out = torch.zeros((n,) + src.shape[1:], dtype=src.dtype)
    return out.index_add_(0, seg, src)
def _pad(x, pw):
    flat = tuple(v for pair in reversed(pw) for v in pair)
    return torch.nn.functional.pad(x, flat)

kernel_name = 'recurrent_scan__sliding_block_cached__glu_gated_bilinear__decode'

def setup_inputs():

    _w = (lambda a: (lambda t: t.to(torch.bfloat16) if t.is_floating_point() else t)(torch.as_tensor(a)))
    def _A_setup():
        B, Sq, D = 1, 1, 640
        Hq, Hkv, Sk, Dh = 32, 32, 8192, 192
        assert Hq % Hkv == 0, (Hq, Hkv)
        return {
            "x": _w((lambda *s: torch.randn(*s, dtype=torch.bfloat16) * 0.2)(B, Sq, D)),
            "k_cache": _w((lambda *s: torch.randn(*s, dtype=torch.bfloat16) * 1.6)(B, Hkv, Sk, Dh)),
            "v_cache": _w((lambda *s: torch.randn(*s, dtype=torch.bfloat16) * 1.6)(B, Hkv, Sk, Dh)),
            "wq": _w((lambda *s: torch.randn(*s, dtype=torch.bfloat16) * 1.6)(D, Hq * Dh) * (D ** -0.5)),
            "wo": _w((lambda *s: torch.randn(*s, dtype=torch.bfloat16) * 1.6)(Hq * Dh, D) * ((Hq * Dh) ** -0.5)),
        }
    _A_in = _A_setup()

    def _B_setup():
        B, S, D, F = 1, 1, 640, 1536
        return {
            "x": _w((lambda *s: torch.randn(*s, dtype=torch.bfloat16) * 0.2)(B, S, D)),
            "w_gate": _w((lambda *s: torch.randn(*s, dtype=torch.bfloat16) * 0.8)(D, F) * (D ** -0.5)),
            "w_up": _w((lambda *s: torch.randn(*s, dtype=torch.bfloat16) * 0.8)(D, F) * (D ** -0.5)),
            "w_down": _w((lambda *s: torch.randn(*s, dtype=torch.bfloat16) * 0.8)(F, D) * (F ** -0.5)),
        }
    _B_in = _B_setup()

    return {
        "A_x": _A_in["x"],
        "A_k_cache": _A_in["k_cache"],
        "A_v_cache": _A_in["v_cache"],
        "A_wq": _A_in["wq"],
        "A_wo": _A_in["wo"],
        "B_x": _B_in["x"],
        "B_w_gate": _B_in["w_gate"],
        "B_w_up": _B_in["w_up"],
        "B_w_down": _B_in["w_down"],
    }

def reference(A_x, A_k_cache, A_v_cache, A_wq, A_wo, B_x, B_w_gate, B_w_up, B_w_down):
    def _A_ref(x, k_cache, v_cache, wq, wo):
        B, Sq, D = x.shape
        Hq, Dh = 32, 192
        Hkv, Sk = k_cache.shape[1], k_cache.shape[2]
        W = min(4096, max(256, Sk // 4))
        rep = Hq // Hkv
        q = (lambda x, *d: x.permute(*d))((x @ wq).reshape(B, Sq, Hq, Dh), 0, 2, 1, 3)
        k = (lambda x, n, axis: torch.repeat_interleave(x, n, dim=axis))(k_cache[:, :, Sk - W:, :], rep, axis=1)
        v = (lambda x, n, axis: torch.repeat_interleave(x, n, dim=axis))(v_cache[:, :, Sk - W:, :], rep, axis=1)
        scores = torch.einsum("bhqd,bhkd->bhqk", q, k) * (Dh ** -0.5)
        p = _softmax(scores, axis=-1)
        o = torch.einsum("bhqk,bhkd->bhqd", p, v)
        return (lambda x, *d: x.permute(*d))(o, 0, 2, 1, 3).reshape(B, Sq, Hq * Dh) @ wo

    def _B_ref(x, w_gate, w_up, w_down):
        g = torch.einsum("bsd,df->bsf", x, w_gate)
        u = torch.einsum("bsd,df->bsf", x, w_up)
        h = g * u
        return torch.einsum("bsf,fd->bsd", h, w_down)

    x = A_x
    xn = _layernorm(x, axis=-1)
    s = _A_ref(xn, A_k_cache, A_v_cache, A_wq, A_wo)
    g = _silu(_B_ref(xn, B_w_gate, B_w_up, B_w_down))
    return x + s * g
```

```asm
; @launch grid=(256,1,1) block=(768,1,1) lds=16384
.amdgcn_target "amdgcn-amd-amdhsa--gfx950"
.text
.globl recurrent_scan__sliding_block_cached__glu_gated_bilinear__decode_kernel
.p2align 8
.type recurrent_scan__sliding_block_cached__glu_gated_bilinear__decode_kernel,@function
recurrent_scan__sliding_block_cached__glu_gated_bilinear__decode_kernel:
    s_cmp_ge_u32 s2, 256
    s_cbranch_scc1 .Lend
    s_load_dwordx16 s[16:31], s[0:1], 0
    s_load_dwordx8 s[32:39], s[0:1], 64
    s_memrealtime s[72:73]
    v_lshrrev_b32 v1, 6, v0
    v_and_b32 v0, 63, v0
    v_readfirstlane_b32 s3, v1
    s_cmp_ge_u32 s3, 4
    s_cbranch_scc1 .Lkv
    s_cmp_eq_u32 s3, 3
    s_cbranch_scc1 .Lffn
    s_setprio 3
    s_and_b32 s7, s2, 7
    s_lshr_b32 s8, s2, 3
    s_lshr_b32 s9, s8, 3
    s_lshl_b32 s4, s7, 2
    s_add_u32 s4, s4, s9
    s_and_b32 s5, s8, 7
    s_lshl_b32 s6, s4, 3
    s_add_u32 s6, s6, s5
    s_mov_b32 s80, 0
    s_mov_b32 s67, 0x3fb8aa3b
    v_mov_b32 v18, 0
    v_mov_b32 v31, 0xff
    v_lshrrev_b32 v2, 3, v0
    v_and_b32 v4, 7, v0
    v_lshlrev_b32 v4, 4, v4
    v_lshlrev_b32 v1, 4, v0
    v_lshlrev_b32 v9, 2, v0
    s_getreg_b32 s65, hwreg(HW_REG_XCC_ID, 0, 4)
    s_lshl_b32 s66, s65, 8
    s_mov_b32 s82, 0
    v_mul_u32_u24 v3, 20, v2
    s_mul_i32 s7, s5, 160
    v_add_u32 v3, s7, v3
    s_mul_i32 s7, s5, 983040
    s_mul_i32 s8, s4, 384
    s_add_u32 s7, s7, s8
    s_lshl_b32 s8, s3, 7
    s_add_u32 s7, s7, s8
    s_mov_b32 s8, 122880
    v_mul_lo_u32 v5, v2, s8
    v_add_u32 v5, v5, v4
    s_or_b32 s9, s2, s3
    s_waitcnt lgkmcnt(0)
    s_cbranch_scc1 .Lnononce
    s_mov_b32 s60, s36
    s_mov_b32 s61, s37
    s_mov_b32 s62, 256
    s_mov_b32 s63, 0x20000
    s_bfe_u32 s10, s72, 0x70004
    s_bfe_u32 s8, s72, 0x7000b
    s_lshl_b32 s8, s8, 8
    s_or_b32 s10, s10, s8
    s_bfe_u32 s8, s72, 0x70012
    s_lshl_b32 s8, s8, 16
    s_or_b32 s10, s10, s8
    s_bfe_u32 s8, s72, 0x60019
    s_lshl_b32 s8, s8, 24
    s_or_b32 s10, s10, s8
    s_or_b32 s10, s10, 0x80808080
    v_mov_b32 v6, s10
    s_mov_b64 exec, 1
    buffer_store_dword v6, v18, s[60:63], 0 offen sc1
    s_mov_b64 exec, -1
.Lnononce:
    s_mov_b32 s40, s16
    s_mov_b32 s41, s17
    s_mov_b32 s42, 1280
    s_mov_b32 s43, 0x20000
    buffer_load_dwordx4 v[10:13], v1, s[40:43], 0 offen
    buffer_load_dword v14, v9, s[40:43], 0 offen offset:1024
    buffer_load_dwordx4 v[36:39], v3, s[40:43], 0 offen
    buffer_load_dword v40, v3, s[40:43], 0 offen offset:16
    s_add_u32 s44, s22, s7
    s_addc_u32 s45, s23, 0
    s_mov_b32 s46, 970880
    s_mov_b32 s47, 0x20000
    s_mov_b32 s7, 0
    buffer_load_dwordx4 v[44:47], v5, s[44:47], s7 offen nt
    s_add_u32 s7, s7, 12288
    buffer_load_dwordx4 v[48:51], v5, s[44:47], s7 offen nt
    s_add_u32 s7, s7, 12288
    buffer_load_dwordx4 v[52:55], v5, s[44:47], s7 offen nt
    s_add_u32 s7, s7, 12288
    buffer_load_dwordx4 v[56:59], v5, s[44:47], s7 offen nt
    s_add_u32 s7, s7, 12288
    buffer_load_dwordx4 v[60:63], v5, s[44:47], s7 offen nt
    s_add_u32 s7, s7, 12288
    buffer_load_dwordx4 v[64:67], v5, s[44:47], s7 offen nt
    s_add_u32 s7, s7, 12288
    buffer_load_dwordx4 v[68:71], v5, s[44:47], s7 offen nt
    s_add_u32 s7, s7, 12288
    buffer_load_dwordx4 v[72:75], v5, s[44:47], s7 offen nt
    s_add_u32 s7, s7, 12288
    buffer_load_dwordx4 v[76:79], v5, s[44:47], s7 offen nt
    s_add_u32 s7, s7, 12288
    buffer_load_dwordx4 v[80:83], v5, s[44:47], s7 offen nt
    s_barrier
    s_mov_b32 s56, s38
    s_mov_b32 s57, s39
    s_mov_b32 s58, 2359296
    s_mov_b32 s59, 0x20000
    s_mov_b32 s60, s36
    s_mov_b32 s61, s37
    s_mov_b32 s62, 256
    s_mov_b32 s63, 0x20000
    s_cmp_lg_u32 s3, 0
    s_cbranch_scc1 .Lnozf
    v_mov_b32 v20, 0
    v_mov_b32 v21, 0
    v_mov_b32 v22, 0
    v_mov_b32 v23, 0
    s_lshl_b32 s7, s6, 10
    s_add_u32 s7, s7, 524288
    buffer_store_dwordx4 v[20:23], v1, s[56:59], s7 offen
.Lnozf:
    buffer_load_dword v19, v18, s[60:63], 0 offen sc1
    v_bfe_u32 v5, v0, 3, 1
    v_mul_u32_u24 v5, 0x202, v5
    v_add_u32 v5, 0x100, v5
    v_and_b32 v6, 1, v0
    v_lshlrev_b32 v6, 4, v6
    v_lshlrev_b32 v5, v6, v5
    v_mov_b32 v7, 0x0c0c0000
    v_lshrrev_b32 v7, v6, v7
    v_or_b32 v5, v5, v7
    v_bfe_u32 v6, v0, 1, 2
    v_mov_b32 v7, 0x0c0c0c0c
    v_cmp_eq_u32 vcc, 0, v6
    s_nop 1
    v_cndmask_b32 v32, v7, v5, vcc
    v_cmp_eq_u32 vcc, 1, v6
    s_nop 1
    v_cndmask_b32 v33, v7, v5, vcc
    v_cmp_eq_u32 vcc, 2, v6
    s_nop 1
    v_cndmask_b32 v34, v7, v5, vcc
    v_cmp_eq_u32 vcc, 3, v6
    s_nop 1
    v_cndmask_b32 v35, v7, v5, vcc
    s_waitcnt vmcnt(11)
    v_lshlrev_b32 v20, 16, v10
    v_and_b32 v21, 0xffff0000, v10
    v_lshlrev_b32 v22, 16, v11
    v_and_b32 v23, 0xffff0000, v11
    v_lshlrev_b32 v24, 16, v12
    v_and_b32 v25, 0xffff0000, v12
    v_lshlrev_b32 v26, 16, v13
    v_and_b32 v27, 0xffff0000, v13
    v_lshlrev_b32 v28, 16, v14
    v_and_b32 v29, 0xffff0000, v14
    v_add_f32 v5, v20, v21
    v_add_f32 v5, v5, v22
    v_add_f32 v5, v5, v23
    v_add_f32 v5, v5, v24
    v_add_f32 v5, v5, v25
    v_add_f32 v5, v5, v26
    v_add_f32 v5, v5, v27
    v_add_f32 v5, v5, v28
    v_add_f32 v5, v5, v29
    s_nop 1
    v_add_f32_dpp v5, v5, v5 quad_perm:[1,0,3,2] row_mask:0xf bank_mask:0xf
    s_nop 1
    v_add_f32_dpp v5, v5, v5 quad_perm:[2,3,0,1] row_mask:0xf bank_mask:0xf
    s_nop 1
    v_add_f32_dpp v5, v5, v5 row_half_mirror row_mask:0xf bank_mask:0xf
    s_nop 1
    v_add_f32_dpp v5, v5, v5 row_mirror row_mask:0xf bank_mask:0xf
    s_nop 0
    v_readlane_b32 s12, v5, 0
    v_readlane_b32 s13, v5, 16
    v_readlane_b32 s14, v5, 32
    v_readlane_b32 s15, v5, 48
    v_mov_b32 v5, s12
    v_add_f32 v5, s13, v5
    v_add_f32 v5, s14, v5
    v_add_f32 v5, s15, v5
    v_mul_f32 v5, 0x3acccccd, v5
    v_sub_f32 v6, v20, v5
    v_mul_f32 v7, v6, v6
    v_sub_f32 v6, v21, v5
    v_fmac_f32 v7, v6, v6
    v_sub_f32 v6, v22, v5
    v_fmac_f32 v7, v6, v6
    v_sub_f32 v6, v23, v5
    v_fmac_f32 v7, v6, v6
    v_sub_f32 v6, v24, v5
    v_fmac_f32 v7, v6, v6
    v_sub_f32 v6, v25, v5
    v_fmac_f32 v7, v6, v6
    v_sub_f32 v6, v26, v5
    v_fmac_f32 v7, v6, v6
    v_sub_f32 v6, v27, v5
    v_fmac_f32 v7, v6, v6
    v_sub_f32 v6, v28, v5
    v_fmac_f32 v7, v6, v6
    v_sub_f32 v6, v29, v5
    v_fmac_f32 v7, v6, v6
    s_nop 1
    v_add_f32_dpp v7, v7, v7 quad_perm:[1,0,3,2] row_mask:0xf bank_mask:0xf
    s_nop 1
    v_add_f32_dpp v7, v7, v7 quad_perm:[2,3,0,1] row_mask:0xf bank_mask:0xf
    s_nop 1
    v_add_f32_dpp v7, v7, v7 row_half_mirror row_mask:0xf bank_mask:0xf
    s_nop 1
    v_add_f32_dpp v7, v7, v7 row_mirror row_mask:0xf bank_mask:0xf
    s_nop 0
    v_readlane_b32 s12, v7, 0
    v_readlane_b32 s13, v7, 16
    v_readlane_b32 s14, v7, 32
    v_readlane_b32 s15, v7, 48
    v_mov_b32 v7, s12
    v_add_f32 v7, s13, v7
    v_add_f32 v7, s14, v7
    v_add_f32 v7, s15, v7
    v_mul_f32 v7, 0x3acccccd, v7
    v_cvt_pk_bf16_f32 v6, v5, v5
    v_lshlrev_b32 v5, 16, v6
    v_cvt_pk_bf16_f32 v6, v7, v7
    v_lshlrev_b32 v7, 16, v6
    v_add_f32 v7, 0x3727c5ac, v7
    v_cvt_pk_bf16_f32 v6, v7, v7
    v_lshlrev_b32 v7, 16, v6
    v_sqrt_f32 v7, v7
    s_nop 0
    v_cvt_pk_bf16_f32 v6, v7, v7
    v_lshlrev_b32 v7, 16, v6
    v_rcp_f32 v8, v7
    v_lshlrev_b32 v10, 16, v36
    v_and_b32 v11, 0xffff0000, v36
    v_sub_f32 v10, v10, v5
    v_sub_f32 v11, v11, v5
    v_cvt_pk_bf16_f32 v6, v10, v11
    v_lshlrev_b32 v10, 16, v6
    v_and_b32 v11, 0xffff0000, v6
    v_mul_f32 v12, v10, v8
    v_fma_f32 v13, -v12, v7, v10
    v_fma_f32 v12, v13, v8, v12
    v_cvt_pk_bf16_f32 v20, v12, v12
    v_mul_f32 v12, v11, v8
    v_fma_f32 v13, -v12, v7, v11
    v_fma_f32 v12, v13, v8, v12
    v_cvt_pk_bf16_f32 v21, v12, v12
    v_lshlrev_b32 v10, 16, v37
    v_and_b32 v11, 0xffff0000, v37
    v_sub_f32 v10, v10, v5
    v_sub_f32 v11, v11, v5
    v_cvt_pk_bf16_f32 v6, v10, v11
    v_lshlrev_b32 v10, 16, v6
    v_and_b32 v11, 0xffff0000, v6
    v_mul_f32 v12, v10, v8
    v_fma_f32 v13, -v12, v7, v10
    v_fma_f32 v12, v13, v8, v12
    v_cvt_pk_bf16_f32 v22, v12, v12
    v_mul_f32 v12, v11, v8
    v_fma_f32 v13, -v12, v7, v11
    v_fma_f32 v12, v13, v8, v12
    v_cvt_pk_bf16_f32 v23, v12, v12
    v_lshlrev_b32 v10, 16, v38
    v_and_b32 v11, 0xffff0000, v38
    v_sub_f32 v10, v10, v5
    v_sub_f32 v11, v11, v5
    v_cvt_pk_bf16_f32 v6, v10, v11
    v_lshlrev_b32 v10, 16, v6
    v_and_b32 v11, 0xffff0000, v6
    v_mul_f32 v12, v10, v8
    v_fma_f32 v13, -v12, v7, v10
    v_fma_f32 v12, v13, v8, v12
    v_cvt_pk_bf16_f32 v24, v12, v12
    v_mul_f32 v12, v11, v8
    v_fma_f32 v13, -v12, v7, v11
    v_fma_f32 v12, v13, v8, v12
    v_cvt_pk_bf16_f32 v25, v12, v12
    v_lshlrev_b32 v10, 16, v39
    v_and_b32 v11, 0xffff0000, v39
    v_sub_f32 v10, v10, v5
    v_sub_f32 v11, v11, v5
    v_cvt_pk_bf16_f32 v6, v10, v11
    v_lshlrev_b32 v10, 16, v6
    v_and_b32 v11, 0xffff0000, v6
    v_mul_f32 v12, v10, v8
    v_fma_f32 v13, -v12, v7, v10
    v_fma_f32 v12, v13, v8, v12
    v_cvt_pk_bf16_f32 v26, v12, v12
    v_mul_f32 v12, v11, v8
    v_fma_f32 v13, -v12, v7, v11
    v_fma_f32 v12, v13, v8, v12
    v_cvt_pk_bf16_f32 v27, v12, v12
    v_lshlrev_b32 v10, 16, v40
    v_and_b32 v11, 0xffff0000, v40
    v_sub_f32 v10, v10, v5
    v_sub_f32 v11, v11, v5
    v_cvt_pk_bf16_f32 v6, v10, v11
    v_lshlrev_b32 v10, 16, v6
    v_and_b32 v11, 0xffff0000, v6
    v_mul_f32 v12, v10, v8
    v_fma_f32 v13, -v12, v7, v10
    v_fma_f32 v12, v13, v8, v12
    v_cvt_pk_bf16_f32 v28, v12, v12
    v_mul_f32 v12, v11, v8
    v_fma_f32 v13, -v12, v7, v11
    v_fma_f32 v12, v13, v8, v12
    v_cvt_pk_bf16_f32 v29, v12, v12
    v_perm_b32 v36, v20, v20, v32
    v_perm_b32 v37, v20, v20, v33
    v_perm_b32 v38, v20, v20, v34
    v_perm_b32 v39, v20, v20, v35
    s_waitcnt vmcnt(10)
    s_nop 0
    v_mfma_f32_16x16x32_bf16 v[84:87], v[36:39], v[44:47], 0
    v_perm_b32 v36, v21, v21, v32
    v_perm_b32 v37, v21, v21, v33
    v_perm_b32 v38, v21, v21, v34
    v_perm_b32 v39, v21, v21, v35
    s_waitcnt vmcnt(9)
    s_nop 0
    v_mfma_f32_16x16x32_bf16 v[84:87], v[36:39], v[48:51], v[84:87]
    v_perm_b32 v36, v22, v22, v32
    v_perm_b32 v37, v22, v22, v33
    v_perm_b32 v38, v22, v22, v34
    v_perm_b32 v39, v22, v22, v35
    s_waitcnt vmcnt(8)
    s_nop 0
    v_mfma_f32_16x16x32_bf16 v[84:87], v[36:39], v[52:55], v[84:87]
    v_perm_b32 v36, v23, v23, v32
    v_perm_b32 v37, v23, v23, v33
    v_perm_b32 v38, v23, v23, v34
    v_perm_b32 v39, v23, v23, v35
    s_waitcnt vmcnt(7)
    s_nop 0
    v_mfma_f32_16x16x32_bf16 v[84:87], v[36:39], v[56:59], v[84:87]
    v_perm_b32 v36, v24, v24, v32
    v_perm_b32 v37, v24, v24, v33
    v_perm_b32 v38, v24, v24, v34
    v_perm_b32 v39, v24, v24, v35
    s_waitcnt vmcnt(6)
    s_nop 0
    v_mfma_f32_16x16x32_bf16 v[84:87], v[36:39], v[60:63], v[84:87]
    v_perm_b32 v36, v25, v25, v32
    v_perm_b32 v37, v25, v25, v33
    v_perm_b32 v38, v25, v25, v34
    v_perm_b32 v39, v25, v25, v35
    s_waitcnt vmcnt(5)
    s_nop 0
    v_mfma_f32_16x16x32_bf16 v[84:87], v[36:39], v[64:67], v[84:87]
    v_perm_b32 v36, v26, v26, v32
    v_perm_b32 v37, v26, v26, v33
    v_perm_b32 v38, v26, v26, v34
    v_perm_b32 v39, v26, v26, v35
    s_waitcnt vmcnt(4)
    s_nop 0
    v_mfma_f32_16x16x32_bf16 v[84:87], v[36:39], v[68:71], v[84:87]
    v_perm_b32 v36, v27, v27, v32
    v_perm_b32 v37, v27, v27, v33
    v_perm_b32 v38, v27, v27, v34
    v_perm_b32 v39, v27, v27, v35
    s_waitcnt vmcnt(3)
    s_nop 0
    v_mfma_f32_16x16x32_bf16 v[84:87], v[36:39], v[72:75], v[84:87]
    v_perm_b32 v36, v28, v28, v32
    v_perm_b32 v37, v28, v28, v33
    v_perm_b32 v38, v28, v28, v34
    v_perm_b32 v39, v28, v28, v35
    s_waitcnt vmcnt(2)
    s_nop 0
    v_mfma_f32_16x16x32_bf16 v[84:87], v[36:39], v[76:79], v[84:87]
    v_perm_b32 v36, v29, v29, v32
    v_perm_b32 v37, v29, v29, v33
    v_perm_b32 v38, v29, v29, v34
    v_perm_b32 v39, v29, v29, v35
    s_waitcnt vmcnt(1)
    s_nop 0
    v_mfma_f32_16x16x32_bf16 v[84:87], v[36:39], v[80:83], v[84:87]
    s_nop 7
    v_mov_b32_dpp v88, v84 row_ror:8 row_mask:0xf bank_mask:0xf
    v_mov_b32_dpp v89, v85 row_ror:8 row_mask:0xf bank_mask:0xf
    v_mov_b32_dpp v90, v86 row_ror:8 row_mask:0xf bank_mask:0xf
    v_mov_b32_dpp v91, v87 row_ror:8 row_mask:0xf bank_mask:0xf
    v_permlane32_swap_b32 v88, v92
    v_permlane32_swap_b32 v89, v93
    v_permlane32_swap_b32 v90, v94
    v_permlane32_swap_b32 v91, v95
    v_add_f32 v84, v84, v92
    v_add_f32 v85, v85, v93
    v_add_f32 v86, v86, v94
    v_add_f32 v87, v87, v95
    v_and_b32 v17, 15, v0
    v_lshlrev_b32 v17, 5, v17
    v_lshrrev_b32 v6, 4, v0
    v_lshl_add_u32 v17, v6, 4, v17
    s_lshl_b32 s10, s3, 16
    s_lshl_b32 s7, s6, 8
    s_add_u32 s10, s10, s7
    s_add_u32 s11, s10, 1048576
    s_lshl_b32 s9, s4, 9
    s_lshl_b32 s7, s3, 7
    s_add_u32 s9, s9, s7
    s_add_u32 s9, s9, 196608
    s_lshl_b32 s7, s5, 4
    s_add_u32 s7, s7, s9
    s_sub_u32 s7, s7, s10
    v_writelane_b32 v17, s7, 8
    v_writelane_b32 v84, s66, 8
    v_writelane_b32 v85, s66, 8
    v_writelane_b32 v86, s66, 8
    v_writelane_b32 v87, s66, 8
    s_lshl_b32 s8, s3, 16
    s_lshl_b32 s7, s4, 11
    s_add_u32 s8, s8, s7
    v_mov_b32 v16, v4
.Lfl_q:
    s_waitcnt vmcnt(0)
    v_readfirstlane_b32 s81, v19
    s_cmp_lg_u32 s81, 0
    s_nop 2
    s_cbranch_scc1 .Lfl_q_ok
    s_sleep 2
    buffer_load_dword v19, v18, s[60:63], 0 offen sc1
    s_add_u32 s80, s80, 1
    s_cmp_lt_u32 s80, 200000
    s_cbranch_scc1 .Lfl_q
    s_branch .Lend
.Lfl_q_ok:
    s_mov_b32 s80, 0
    s_lshr_b32 s61, s81, 8
    s_lshr_b32 s62, s81, 16
    s_lshr_b32 s63, s81, 24
    v_bfi_b32 v84, v31, s81, v84
    v_bfi_b32 v85, v31, s61, v85
    v_bfi_b32 v86, v31, s62, v86
    v_bfi_b32 v87, v31, s63, v87
    s_mov_b64 exec, 0x00ff01ff
    buffer_store_dwordx4 v[84:87], v17, s[56:59], s10 offen
    s_mov_b64 exec, -1
    v_mov_b32 v15, v1
    s_sleep 40
.Lqg:
    buffer_load_dwordx4 v[44:47], v15, s[56:59], s8 offen sc1
    buffer_load_dwordx4 v[48:51], v15, s[56:59], s8 offen offset:1024 sc1
    s_mov_b64 exec, 0xff
    buffer_load_dwordx4 v[52:55], v16, s[56:59], s9 offen sc1
    s_mov_b64 exec, 0xff
    s_waitcnt vmcnt(0)
    v_xor_b32 v5, s81, v52
    v_bitop3_b32 v5, v5, v53, s61 bitop3:0xf6
    v_bitop3_b32 v5, v5, v54, s62 bitop3:0xf6
    v_bitop3_b32 v5, v5, v55, s63 bitop3:0xf6
    v_and_b32 v5, v31, v5
    v_cmp_ne_u32 vcc, 0, v5
    s_cbranch_vccz .Lqg_id
    s_mov_b64 exec, -1
    s_branch .Lqg_re
.Lqg_id:
    s_mov_b64 exec, -1
    v_xor_b32 v5, s81, v44
    v_bitop3_b32 v5, v5, v45, s61 bitop3:0xf6
    v_bitop3_b32 v5, v5, v46, s62 bitop3:0xf6
    v_bitop3_b32 v5, v5, v47, s63 bitop3:0xf6
    v_bitop3_b32 v5, v5, v48, s81 bitop3:0xf6
    v_bitop3_b32 v5, v5, v49, s61 bitop3:0xf6
    v_bitop3_b32 v5, v5, v50, s62 bitop3:0xf6
    v_bitop3_b32 v5, v5, v51, s63 bitop3:0xf6
    v_and_b32 v5, v31, v5
    v_cmp_ne_u32 vcc, 0, v5
    s_cbranch_vccz .Lqg_ok
.Lqg_re:
    s_sleep 16
    s_add_u32 s80, s80, 1
    s_cmp_lt_u32 s80, 6
    s_cbranch_scc1 .Lqg
    s_cmp_lg_u32 s82, 0
    s_cbranch_scc1 .Lfb_q
    s_mov_b64 exec, 0x00ff01ff
    buffer_store_dwordx4 v[84:87], v17, s[56:59], s11 offen sc1
    s_mov_b64 exec, -1
    s_mov_b32 s82, 1
.Lfb_q:
    v_xor_b32 v15, 0x100000, v15
    v_xor_b32 v16, 0x100000, v16
    s_cmp_lt_u32 s80, 200000
    s_cbranch_scc1 .Lqg
    s_branch .Lend
.Lqg_ok:
    s_mov_b64 exec, 0xff
    s_mov_b32 s80, 0
    s_mov_b32 s83, 0
    v_lshrrev_b32 v5, 8, v52
    v_cmp_ne_u32 vcc, s65, v5
    s_nop 0
    s_cbranch_vccz .Lxc_q
    s_mov_b32 s83, 0x100000
    s_cmp_lg_u32 s82, 0
    s_cbranch_scc1 .Lxc_q
    s_mov_b64 exec, 0x00ff01ff
    buffer_store_dwordx4 v[84:87], v17, s[56:59], s11 offen sc1
    s_mov_b64 exec, -1
.Lxc_q:
    s_mov_b64 exec, -1
    v_and_b32 v44, 0xffffff00, v44
    v_and_b32 v45, 0xffffff00, v45
    v_and_b32 v46, 0xffffff00, v46
    v_and_b32 v47, 0xffffff00, v47
    v_and_b32 v48, 0xffffff00, v48
    v_and_b32 v49, 0xffffff00, v49
    v_and_b32 v50, 0xffffff00, v50
    v_and_b32 v51, 0xffffff00, v51
    v_add_f32 v44, v44, v48
    v_add_f32 v45, v45, v49
    v_add_f32 v46, v46, v50
    v_add_f32 v47, v47, v51
    v_mov_b32 v48, v44
    v_mov_b32 v49, v45
    v_mov_b32 v50, v46
    v_mov_b32 v51, v47
    v_permlane16_swap_b32 v44, v48
    v_permlane16_swap_b32 v45, v49
    v_permlane16_swap_b32 v46, v50
    v_permlane16_swap_b32 v47, v51
    v_add_f32 v44, v44, v48
    v_add_f32 v45, v45, v49
    v_add_f32 v46, v46, v50
    v_add_f32 v47, v47, v51
    v_mov_b32 v48, v44
    v_mov_b32 v49, v45
    v_mov_b32 v50, v46
    v_mov_b32 v51, v47
    v_permlane32_swap_b32 v44, v48
    v_permlane32_swap_b32 v45, v49
    v_permlane32_swap_b32 v46, v50
    v_permlane32_swap_b32 v47, v51
    v_add_f32 v44, v44, v48
    v_add_f32 v45, v45, v49
    v_add_f32 v46, v46, v50
    v_add_f32 v47, v47, v51
    v_cvt_pk_bf16_f32 v6, v44, v45
    v_cvt_pk_bf16_f32 v7, v46, v47
    s_lshl_b32 s7, s3, 7
    v_and_b32 v5, 15, v0
    v_lshlrev_b32 v5, 3, v5
    v_add_u32 v5, s7, v5
    ds_write_b64 v5, v[6:7] offset:0
    v_mov_b32 v5, s83
    ds_write_b32 v18, v5 offset:460
    s_lshl_b32 s7, s3, 2
    v_mov_b32 v6, s7
    v_mov_b32 v5, s81
    s_waitcnt lgkmcnt(0)
    ds_write_b32 v6, v5 offset:448
    s_lshl_b32 s75, s4, 13
    s_lshl_b32 s7, s5, 4
    s_add_u32 s75, s75, s7
    s_add_u32 s75, s75, 524288
    s_add_u32 s75, s75, s83
    s_lshl_b32 s76, s4, 9
    s_add_u32 s76, s76, s7
    s_add_u32 s76, s76, 196992
    s_add_u32 s76, s76, s83
    s_lshl_b32 s7, s3, 6
    v_add_u32 v24, s7, v0
    v_mul_u32_u24 v22, 0x5556, v24
    v_lshrrev_b32 v22, 16, v22
    v_mul_u32_u24 v21, 3, v22
    v_sub_u32 v21, v24, v21
    v_lshlrev_b32 v22, 7, v22
    v_lshl_add_u32 v22, v21, 2, v22
    v_lshlrev_b32 v21, 3, v21
    v_lshrrev_b32 v30, v21, s81
    v_lshlrev_b32 v24, 2, v24
    s_mov_b32 s70, 0
    s_cmp_lg_u32 s3, 0
    s_cbranch_scc1 .Lnoz
    s_and_b32 s74, s6, 31
    s_cmp_ge_u32 s74, 10
    s_cbranch_scc1 .Lnoz
    s_mov_b32 s70, 1
    s_lshr_b32 s7, s6, 5
    s_mul_i32 s8, s7, 160
    s_lshl_b32 s9, s74, 4
    s_add_u32 s8, s8, s9
    v_and_b32 v5, 1, v0
    v_lshlrev_b32 v25, 3, v5
    v_bfe_u32 v6, v0, 4, 1
    v_lshl_add_u32 v25, v6, 2, v25
    v_lshrrev_b32 v6, 5, v0
    v_lshl_add_u32 v25, v6, 1, v25
    v_add_u32 v25, s8, v25
    s_lshl_b32 s9, s8, 6
    s_add_u32 s73, s9, 2097152
    v_lshrrev_b32 v28, 1, v0
    v_mul_u32_u24 v28, 3072, v28
    v_lshl_add_u32 v28, v5, 4, v28
    s_mul_i32 s71, s7, 384
    s_lshl_b32 s9, s74, 5
    s_add_u32 s71, s71, s9
    s_add_u32 s71, s71, 2228224
    s_mov_b32 s78, 0x00030003
    s_mov_b32 s79, 0x00030003
    s_mov_b32 s48, s34
    s_mov_b32 s49, s35
    s_mov_b32 s50, 1280
    s_mov_b32 s51, 0x20000
.Lnoz:
    s_cmp_eq_u32 s83, 0
    s_cbranch_scc1 .Lnozb
    s_cmp_lg_u32 s3, 2
    s_cbranch_scc1 .Lnozb
    v_mov_b32 v64, 0
    v_mov_b32 v65, 0
    v_mov_b32 v66, 0
    v_mov_b32 v67, 0
    v_lshlrev_b32 v12, 7, v0
    buffer_store_dwordx4 v[64:67], v12, s[56:59], s75 offen sc1
    s_waitcnt vmcnt(0)
.Lnozb:
.Lms:
    ds_read_b128 v[40:43], v18 offset:384
    ds_read_b128 v[44:47], v18 offset:400
    ds_read_b128 v[48:51], v18 offset:416
    ds_read_b128 v[52:55], v18 offset:432
    s_waitcnt lgkmcnt(0)
    v_max3_u32 v19, v40, v41, v42
    v_max3_u32 v19, v19, v43, v44
    v_max3_u32 v19, v19, v45, v46
    v_max3_u32 v19, v19, v47, v48
    v_max3_u32 v19, v19, v49, v50
    v_max3_u32 v19, v19, v51, v52
    v_max3_u32 v19, v19, v53, v54
    v_max_u32 v19, v19, v55
    v_cmp_eq_u32 vcc, -1, v19
    s_nop 0
    s_cbranch_vccz .Lms_ok
    s_sleep 2
    s_add_u32 s80, s80, 1
    s_cmp_lt_u32 s80, 2000000
    s_cbranch_scc1 .Lms
    s_branch .Lend
.Lms_ok:
    s_mov_b32 s80, 0
    v_max3_f32 v10, v40, v41, v42
    v_max3_f32 v10, v10, v43, v44
    v_max3_f32 v10, v10, v45, v46
    v_max_f32 v10, v10, v47
    v_sub_f32 v40, v40, v10
    v_sub_f32 v41, v41, v10
    v_sub_f32 v42, v42, v10
    v_sub_f32 v43, v43, v10
    v_sub_f32 v44, v44, v10
    v_sub_f32 v45, v45, v10
    v_sub_f32 v46, v46, v10
    v_sub_f32 v47, v47, v10
    v_mul_f32 v40, s67, v40
    v_mul_f32 v41, s67, v41
    v_mul_f32 v42, s67, v42
    v_mul_f32 v43, s67, v43
    v_mul_f32 v44, s67, v44
    v_mul_f32 v45, s67, v45
    v_mul_f32 v46, s67, v46
    v_mul_f32 v47, s67, v47
    v_exp_f32 v40, v40
    v_exp_f32 v41, v41
    v_exp_f32 v42, v42
    v_exp_f32 v43, v43
    v_exp_f32 v44, v44
    v_exp_f32 v45, v45
    v_exp_f32 v46, v46
    v_exp_f32 v47, v47
    s_cmp_lg_u32 s3, 2
    s_cbranch_scc1 .Lnol
    v_mul_f32 v11, v40, v48
    v_fmac_f32 v11, v41, v49
    v_fmac_f32 v11, v42, v50
    v_fmac_f32 v11, v43, v51
    v_fmac_f32 v11, v44, v52
    v_fmac_f32 v11, v45, v53
    v_fmac_f32 v11, v46, v54
    v_fmac_f32 v11, v47, v55
    v_bfi_b32 v56, v31, s81, v10
    v_bfi_b32 v57, v31, s61, v11
    v_bfi_b32 v58, v31, s62, v10
    v_bfi_b32 v59, v31, s63, v11
    s_mov_b64 exec, 1
    s_cmp_lg_u32 s83, 0
    s_cbranch_scc1 .Lml_b
    buffer_store_dwordx4 v[56:59], v18, s[56:59], s76 offen
    s_nop 0
    s_branch .Lml_e
.Lml_b:
    buffer_store_dwordx4 v[56:59], v18, s[56:59], s76 offen sc1
.Lml_e:
    s_lshl_b32 s7, s5, 4
    s_sub_u32 s76, s76, s7
    s_mov_b64 exec, 0xff
.Lml:
    buffer_load_dwordx4 v[60:63], v4, s[56:59], s76 offen sc1
    s_waitcnt vmcnt(0)
    v_xor_b32 v5, s81, v60
    v_bitop3_b32 v5, v5, v61, s61 bitop3:0xf6
    v_bitop3_b32 v5, v5, v62, s62 bitop3:0xf6
    v_bitop3_b32 v5, v5, v63, s63 bitop3:0xf6
    v_and_b32 v5, v31, v5
    v_cmp_ne_u32 vcc, 0, v5
    s_cbranch_vccz .Lml_ok
    s_sleep 4
    s_add_u32 s80, s80, 1
    s_cmp_lt_u32 s80, 200000
    s_cbranch_scc1 .Lml
    s_branch .Lend
.Lml_ok:
    s_mov_b32 s80, 0
    v_and_b32 v60, 0xffffff00, v60
    v_and_b32 v61, 0xffffff00, v61
    v_mov_b32 v62, v60
    s_nop 1
    v_max_f32_dpp v62, v62, v62 quad_perm:[1,0,3,2] row_mask:0xf bank_mask:0xf
    s_nop 1
    v_max_f32_dpp v62, v62, v62 quad_perm:[2,3,0,1] row_mask:0xf bank_mask:0xf
    s_nop 1
    v_max_f32_dpp v62, v62, v62 row_half_mirror row_mask:0xf bank_mask:0xf
    v_sub_f32 v60, v60, v62
    v_sub_f32 v62, v10, v62
    v_mul_f32 v60, s67, v60
    v_mul_f32 v62, s67, v62
    v_exp_f32 v60, v60
    v_exp_f32 v62, v62
    v_mul_f32 v60, v60, v61
    s_nop 1
    v_add_f32_dpp v60, v60, v60 quad_perm:[1,0,3,2] row_mask:0xf bank_mask:0xf
    s_nop 1
    v_add_f32_dpp v60, v60, v60 quad_perm:[2,3,0,1] row_mask:0xf bank_mask:0xf
    s_nop 1
    v_add_f32_dpp v60, v60, v60 row_half_mirror row_mask:0xf bank_mask:0xf
    v_rcp_f32 v60, v60
    s_nop 0
    v_mul_f32 v60, v60, v62
    ds_write_b32 v18, v60 offset:468
    s_mov_b64 exec, -1
.Lnol:
    s_cmp_eq_u32 s70, 0
    s_cbranch_scc1 .Lnozl
    buffer_load_ushort v26, v25, s[40:43], 0 offen
    buffer_load_dwordx4 v[100:103], v1, s[56:59], s73 offen sc1
.Lnozl:
    s_mul_i32 s77, s6, 384
    s_add_u32 s77, s77, 2228224
    v_mov_b32 v23, v1
    s_cmp_lg_u32 s83, 0
    s_waitcnt lgkmcnt(0)
    s_barrier
    ds_read_b32 v81, v18 offset:468
    ds_read2st64_b32 v[64:65], v24 offset0:4 offset1:7
    ds_read2st64_b32 v[66:67], v24 offset0:10 offset1:13
    ds_read2st64_b32 v[68:69], v24 offset0:16 offset1:19
    ds_read2st64_b32 v[70:71], v24 offset0:22 offset1:25
    ds_read2st64_b32 v[72:73], v24 offset0:28 offset1:31
    ds_read2st64_b32 v[74:75], v24 offset0:34 offset1:37
    ds_read2st64_b32 v[76:77], v24 offset0:40 offset1:43
    ds_read2st64_b32 v[78:79], v24 offset0:46 offset1:49
    s_waitcnt lgkmcnt(7)
    v_add_f32 v64, v64, v65
    v_mul_f32 v82, v40, v64
    s_waitcnt lgkmcnt(6)
    v_add_f32 v66, v66, v67
    v_mul_f32 v83, v41, v66
    s_waitcnt lgkmcnt(5)
    v_add_f32 v68, v68, v69
    v_fmac_f32 v82, v42, v68
    s_waitcnt lgkmcnt(4)
    v_add_f32 v70, v70, v71
    v_fmac_f32 v83, v43, v70
    s_waitcnt lgkmcnt(3)
    v_add_f32 v72, v72, v73
    v_fmac_f32 v82, v44, v72
    s_waitcnt lgkmcnt(2)
    v_add_f32 v74, v74, v75
    v_fmac_f32 v83, v45, v74
    s_waitcnt lgkmcnt(1)
    v_add_f32 v76, v76, v77
    v_fmac_f32 v82, v46, v76
    s_waitcnt lgkmcnt(0)
    v_add_f32 v78, v78, v79
    v_fmac_f32 v83, v47, v78
    v_add_f32 v80, v82, v83
    v_mul_f32 v80, v80, v81
    v_bfi_b32 v80, v31, v30, v80
    s_cbranch_scc1 .Lo_b
    buffer_store_dword v80, v22, s[56:59], s75 offen
.Lo_e:
    s_cmp_eq_u32 s3, 1
    s_cbranch_scc1 .Lyred
    s_cmp_eq_u32 s70, 0
    s_cbranch_scc1 .Lfin_stamp
    s_waitcnt vmcnt(1)
    v_xor_b32 v5, s81, v100
    v_bitop3_b32 v5, v5, v101, s61 bitop3:0xf6
    v_bitop3_b32 v5, v5, v102, s62 bitop3:0xf6
    v_bitop3_b32 v5, v5, v103, s63 bitop3:0xf6
    v_and_b32 v5, v31, v5
    v_cmp_ne_u32 vcc, 0, v5
    s_cbranch_vccz .Lzg_ok
    s_barrier
    s_mov_b32 s70, 2
.Lzg:
    buffer_load_dwordx4 v[100:103], v1, s[56:59], s73 offen sc1
    s_waitcnt vmcnt(0)
    v_xor_b32 v5, s81, v100
    v_bitop3_b32 v5, v5, v101, s61 bitop3:0xf6
    v_bitop3_b32 v5, v5, v102, s62 bitop3:0xf6
    v_bitop3_b32 v5, v5, v103, s63 bitop3:0xf6
    v_and_b32 v5, v31, v5
    v_cmp_ne_u32 vcc, 0, v5
    s_cbranch_vccz .Lzg_ok
    s_add_u32 s80, s80, 1
    s_cmp_lt_u32 s80, 200000
    s_cbranch_scc1 .Lzg
    s_branch .Lend
.Lzg_ok:
    s_mov_b32 s80, 0
    v_and_b32 v100, 0xffffff00, v100
    v_and_b32 v101, 0xffffff00, v101
    v_and_b32 v102, 0xffffff00, v102
    v_and_b32 v103, 0xffffff00, v103
    v_permlane32_swap_b32 v100, v101
    s_nop 0
    v_permlane32_swap_b32 v102, v103
    v_add_f32 v100, v100, v101
    v_add_f32 v102, v102, v103
    s_nop 1
    v_permlane16_swap_b32 v100, v102
    v_add_f32 v100, v100, v102
    s_nop 1
    v_add_f32_dpp v100, v100, v100 row_ror:2 row_mask:0xf bank_mask:0xf
    s_nop 1
    v_add_f32_dpp v100, v100, v100 row_ror:4 row_mask:0xf bank_mask:0xf
    s_nop 1
    v_add_f32_dpp v100, v100, v100 row_ror:8 row_mask:0xf bank_mask:0xf
    v_cvt_pk_bf16_f32 v104, v100, v100
    v_lshlrev_b32 v100, 16, v104
    v_mul_f32 v104, s67, v100
    v_exp_f32 v104, -v104
    s_nop 0
    v_add_f32 v104, 1.0, v104
    v_rcp_f32 v105, v104
    s_nop 0
    v_mul_f32 v106, v100, v105
    v_fma_f32 v107, -v106, v104, v100
    v_fma_f32 v107, v107, v105, v106
    v_cmp_o_f32 vcc, v107, v107
    s_nop 1
    v_cndmask_b32 v100, v106, v107, vcc
    v_cvt_pk_bf16_f32 v104, v100, v100
    v_lshlrev_b32 v100, 16, v104
    v_lshlrev_b32 v108, 16, v26
    s_cmp_eq_u32 s70, 2
    s_cbranch_scc1 .Lyg
    s_barrier
.Lyg:
    buffer_load_dwordx4 v[92:95], v28, s[56:59], s71 offen sc1
    s_waitcnt vmcnt(0)
    v_xor_b32 v5, s81, v92
    v_bitop3_b32 v5, v5, v93, s61 bitop3:0xf6
    v_bitop3_b32 v5, v5, v94, s62 bitop3:0xf6
    v_bitop3_b32 v5, v5, v95, s63 bitop3:0xf6
    v_and_b32 v5, v31, v5
    v_cmp_ne_u32 vcc, 0, v5
    s_cbranch_vccz .Lyg_ok
    s_add_u32 s80, s80, 1
    s_cmp_lt_u32 s80, 200000
    s_cbranch_scc1 .Lyg
    s_branch .Lend
.Lyg_ok:
    v_and_b32 v84, 0xffffff00, v92
    v_and_b32 v85, 0xffffff00, v93
    v_and_b32 v86, 0xffffff00, v94
    v_and_b32 v87, 0xffffff00, v95
.Lyg_c:
    v_permlane32_swap_b32 v84, v85
    s_nop 0
    v_permlane32_swap_b32 v86, v87
    v_add_f32 v84, v84, v85
    v_add_f32 v86, v86, v87
    s_nop 1
    v_permlane16_swap_b32 v84, v86
    v_add_f32 v84, v84, v86
    s_nop 1
    v_add_f32_dpp v84, v84, v84 row_ror:2 row_mask:0xf bank_mask:0xf
    s_nop 1
    v_add_f32_dpp v84, v84, v84 row_ror:4 row_mask:0xf bank_mask:0xf
    s_nop 1
    v_add_f32_dpp v84, v84, v84 row_ror:8 row_mask:0xf bank_mask:0xf
    v_cvt_pk_bf16_f32 v88, v84, v84
    v_lshlrev_b32 v84, 16, v88
    v_mul_f32 v84, v84, v100
    v_cvt_pk_bf16_f32 v88, v84, v84
    v_lshlrev_b32 v84, 16, v88
    v_add_f32 v84, v84, v108
    v_cvt_pk_bf16_f32 v88, v84, v84
    s_mov_b64 exec, s[78:79]
    buffer_store_short v88, v25, s[48:51], 0 offen
.Lfin_stamp:
    s_endpgm
.Lo_b:
    buffer_store_dword v80, v22, s[56:59], s75 offen sc1
    s_branch .Lo_e
.Lyred:
    s_mov_b64 exec, 0xfffff
    s_barrier
    ds_read_b128 v[84:87], v1 offset:13312
    ds_read_b128 v[88:91], v1 offset:13696
    ds_read_b128 v[92:95], v1 offset:14080
    ds_read_b128 v[96:99], v1 offset:14464
    ds_read_b128 v[100:103], v1 offset:14848
    ds_read_b128 v[104:107], v1 offset:15232
    ds_read_b128 v[108:111], v1 offset:15616
    ds_read_b128 v[112:115], v1 offset:16000
    s_waitcnt lgkmcnt(6)
    v_add_f32 v84, v84, v88
    v_add_f32 v85, v85, v89
    v_add_f32 v86, v86, v90
    v_add_f32 v87, v87, v91
    s_waitcnt lgkmcnt(4)
    v_add_f32 v92, v92, v96
    v_add_f32 v93, v93, v97
    v_add_f32 v94, v94, v98
    v_add_f32 v95, v95, v99
    v_add_f32 v84, v84, v92
    v_add_f32 v85, v85, v93
    v_add_f32 v86, v86, v94
    v_add_f32 v87, v87, v95
    s_waitcnt lgkmcnt(2)
    v_add_f32 v100, v100, v104
    v_add_f32 v101, v101, v105
    v_add_f32 v102, v102, v106
    v_add_f32 v103, v103, v107
    s_waitcnt lgkmcnt(0)
    v_add_f32 v108, v108, v112
    v_add_f32 v109, v109, v113
    v_add_f32 v110, v110, v114
    v_add_f32 v111, v111, v115
    v_add_f32 v100, v100, v108
    v_add_f32 v101, v101, v109
    v_add_f32 v102, v102, v110
    v_add_f32 v103, v103, v111
    v_add_f32 v84, v84, v100
    v_add_f32 v85, v85, v101
    v_add_f32 v86, v86, v102
    v_add_f32 v87, v87, v103
    v_bfi_b32 v84, v31, s81, v84
    v_bfi_b32 v85, v31, s61, v85
    v_bfi_b32 v86, v31, s62, v86
    v_bfi_b32 v87, v31, s63, v87
    buffer_store_dwordx4 v[84:87], v23, s[56:59], s77 offen sc1
    s_nop 0
    s_branch .Lfin_stamp
.Lffn:
    s_setprio 3
    s_and_b32 s7, s2, 7
    s_lshr_b32 s8, s2, 3
    s_lshr_b32 s9, s8, 3
    s_lshl_b32 s4, s7, 2
    s_add_u32 s4, s4, s9
    s_and_b32 s5, s8, 7
    s_lshl_b32 s6, s4, 3
    s_add_u32 s6, s6, s5
    s_mov_b32 s80, 0
    s_mov_b32 s67, 0x3fb8aa3b
    v_mov_b32 v18, 0
    v_mov_b32 v31, 0xff
    v_lshrrev_b32 v2, 3, v0
    v_and_b32 v4, 7, v0
    v_lshlrev_b32 v4, 4, v4
    v_lshlrev_b32 v1, 4, v0
    v_lshlrev_b32 v9, 2, v0
    s_getreg_b32 s65, hwreg(HW_REG_XCC_ID, 0, 4)
    s_lshl_b32 s66, s65, 8
    s_mov_b32 s82, 0
    s_and_b32 s68, s6, 15
    s_lshr_b32 s69, s6, 4
    v_lshrrev_b32 v42, 4, v0
    v_and_b32 v43, 15, v0
    v_mul_u32_u24 v3, 20, v42
    s_mul_i32 s7, s68, 80
    v_add_u32 v3, s7, v3
    s_mul_i32 s7, s68, 122880
    s_mul_i32 s8, s69, 192
    s_add_u32 s7, s7, s8
    v_mul_u32_u24 v5, 30720, v42
    v_lshl_add_u32 v5, v43, 4, v5
    v_cmp_gt_u32 vcc, 12, v43
    v_mov_b32 v6, 0x7ffffff0
    s_nop 0
    v_cndmask_b32 v5, v6, v5, vcc
    s_waitcnt lgkmcnt(0)
    s_mov_b32 s40, s16
    s_mov_b32 s41, s17
    s_mov_b32 s42, 1280
    s_mov_b32 s43, 0x20000
    buffer_load_dwordx4 v[10:13], v1, s[40:43], 0 offen
    buffer_load_dword v14, v9, s[40:43], 0 offen offset:1024
    buffer_load_dwordx4 v[36:39], v3, s[40:43], 0 offen
    buffer_load_dword v40, v3, s[40:43], 0 offen offset:16
    s_add_u32 s44, s28, s7
    s_addc_u32 s45, s29, 0
    s_mov_b32 s46, 120000
    s_mov_b32 s47, 0x20000
    s_add_u32 s48, s30, s7
    s_addc_u32 s49, s31, 0
    s_mov_b32 s50, 120000
    s_mov_b32 s51, 0x20000
    s_mov_b32 s7, 0
    buffer_load_dwordx4 v[44:47], v5, s[44:47], s7 offen nt
    buffer_load_dwordx4 v[84:87], v5, s[48:51], s7 offen nt
    s_add_u32 s7, s7, 3072
    buffer_load_dwordx4 v[48:51], v5, s[44:47], s7 offen nt
    buffer_load_dwordx4 v[88:91], v5, s[48:51], s7 offen nt
    s_add_u32 s7, s7, 3072
    buffer_load_dwordx4 v[52:55], v5, s[44:47], s7 offen nt
    buffer_load_dwordx4 v[92:95], v5, s[48:51], s7 offen nt
    s_add_u32 s7, s7, 3072
    buffer_load_dwordx4 v[56:59], v5, s[44:47], s7 offen nt
    buffer_load_dwordx4 v[96:99], v5, s[48:51], s7 offen nt
    s_add_u32 s7, s7, 3072
    buffer_load_dwordx4 v[60:63], v5, s[44:47], s7 offen nt
    buffer_load_dwordx4 v[100:103], v5, s[48:51], s7 offen nt
    s_add_u32 s7, s7, 3072
    s_barrier
    buffer_load_dwordx4 v[64:67], v5, s[44:47], s7 offen nt
    buffer_load_dwordx4 v[104:107], v5, s[48:51], s7 offen nt
    s_add_u32 s7, s7, 3072
    buffer_load_dwordx4 v[68:71], v5, s[44:47], s7 offen nt
    buffer_load_dwordx4 v[108:111], v5, s[48:51], s7 offen nt
    s_add_u32 s7, s7, 3072
    buffer_load_dwordx4 v[72:75], v5, s[44:47], s7 offen nt
    buffer_load_dwordx4 v[112:115], v5, s[48:51], s7 offen nt
    s_add_u32 s7, s7, 3072
    buffer_load_dwordx4 v[76:79], v5, s[44:47], s7 offen nt
    buffer_load_dwordx4 v[116:119], v5, s[48:51], s7 offen nt
    s_add_u32 s7, s7, 3072
    buffer_load_dwordx4 v[80:83], v5, s[44:47], s7 offen nt
    buffer_load_dwordx4 v[120:123], v5, s[48:51], s7 offen nt
    s_mov_b32 s56, s38
    s_mov_b32 s57, s39
    s_mov_b32 s58, 2359296
    s_mov_b32 s59, 0x20000
    s_mov_b32 s60, s36
    s_mov_b32 s61, s37
    s_mov_b32 s62, 256
    s_mov_b32 s63, 0x20000
    buffer_load_dword v19, v18, s[60:63], 0 offen sc1
    v_bfe_u32 v5, v0, 3, 1
    v_mul_u32_u24 v5, 0x202, v5
    v_add_u32 v5, 0x100, v5
    v_and_b32 v7, 1, v0
    v_lshlrev_b32 v7, 4, v7
    v_lshlrev_b32 v5, v7, v5
    v_mov_b32 v8, 0x0c0c0000
    v_lshrrev_b32 v8, v7, v8
    v_or_b32 v5, v5, v8
    v_bfe_u32 v7, v0, 1, 2
    v_mov_b32 v8, 0x0c0c0c0c
    v_cmp_eq_u32 vcc, 0, v7
    s_nop 1
    v_cndmask_b32 v32, v8, v5, vcc
    v_cmp_eq_u32 vcc, 1, v7
    s_nop 1
    v_cndmask_b32 v33, v8, v5, vcc
    v_cmp_eq_u32 vcc, 2, v7
    s_nop 1
    v_cndmask_b32 v34, v8, v5, vcc
    v_cmp_eq_u32 vcc, 3, v7
    s_nop 1
    v_cndmask_b32 v35, v8, v5, vcc
    s_waitcnt vmcnt(21)
    v_lshlrev_b32 v20, 16, v10
    v_and_b32 v21, 0xffff0000, v10
    v_lshlrev_b32 v22, 16, v11
    v_and_b32 v23, 0xffff0000, v11
    v_lshlrev_b32 v24, 16, v12
    v_and_b32 v25, 0xffff0000, v12
    v_lshlrev_b32 v26, 16, v13
    v_and_b32 v27, 0xffff0000, v13
    v_lshlrev_b32 v28, 16, v14
    v_and_b32 v29, 0xffff0000, v14
    v_add_f32 v5, v20, v21
    v_add_f32 v5, v5, v22
    v_add_f32 v5, v5, v23
    v_add_f32 v5, v5, v24
    v_add_f32 v5, v5, v25
    v_add_f32 v5, v5, v26
    v_add_f32 v5, v5, v27
    v_add_f32 v5, v5, v28
    v_add_f32 v5, v5, v29
    s_nop 1
    v_add_f32_dpp v5, v5, v5 quad_perm:[1,0,3,2] row_mask:0xf bank_mask:0xf
    s_nop 1
    v_add_f32_dpp v5, v5, v5 quad_perm:[2,3,0,1] row_mask:0xf bank_mask:0xf
    s_nop 1
    v_add_f32_dpp v5, v5, v5 row_half_mirror row_mask:0xf bank_mask:0xf
    s_nop 1
    v_add_f32_dpp v5, v5, v5 row_mirror row_mask:0xf bank_mask:0xf
    s_nop 0
    v_readlane_b32 s12, v5, 0
    v_readlane_b32 s13, v5, 16
    v_readlane_b32 s14, v5, 32
    v_readlane_b32 s15, v5, 48
    v_mov_b32 v5, s12
    v_add_f32 v5, s13, v5
    v_add_f32 v5, s14, v5
    v_add_f32 v5, s15, v5
    v_mul_f32 v5, 0x3acccccd, v5
    v_sub_f32 v6, v20, v5
    v_mul_f32 v7, v6, v6
    v_sub_f32 v6, v21, v5
    v_fmac_f32 v7, v6, v6
    v_sub_f32 v6, v22, v5
    v_fmac_f32 v7, v6, v6
    v_sub_f32 v6, v23, v5
    v_fmac_f32 v7, v6, v6
    v_sub_f32 v6, v24, v5
    v_fmac_f32 v7, v6, v6
    v_sub_f32 v6, v25, v5
    v_fmac_f32 v7, v6, v6
    v_sub_f32 v6, v26, v5
    v_fmac_f32 v7, v6, v6
    v_sub_f32 v6, v27, v5
    v_fmac_f32 v7, v6, v6
    v_sub_f32 v6, v28, v5
    v_fmac_f32 v7, v6, v6
    v_sub_f32 v6, v29, v5
    v_fmac_f32 v7, v6, v6
    s_nop 1
    v_add_f32_dpp v7, v7, v7 quad_perm:[1,0,3,2] row_mask:0xf bank_mask:0xf
    s_nop 1
    v_add_f32_dpp v7, v7, v7 quad_perm:[2,3,0,1] row_mask:0xf bank_mask:0xf
    s_nop 1
    v_add_f32_dpp v7, v7, v7 row_half_mirror row_mask:0xf bank_mask:0xf
    s_nop 1
    v_add_f32_dpp v7, v7, v7 row_mirror row_mask:0xf bank_mask:0xf
    s_nop 0
    v_readlane_b32 s12, v7, 0
    v_readlane_b32 s13, v7, 16
    v_readlane_b32 s14, v7, 32
    v_readlane_b32 s15, v7, 48
    v_mov_b32 v7, s12
    v_add_f32 v7, s13, v7
    v_add_f32 v7, s14, v7
    v_add_f32 v7, s15, v7
    v_mul_f32 v7, 0x3acccccd, v7
    v_cvt_pk_bf16_f32 v6, v5, v5
    v_lshlrev_b32 v5, 16, v6
    v_cvt_pk_bf16_f32 v6, v7, v7
    v_lshlrev_b32 v7, 16, v6
    v_add_f32 v7, 0x3727c5ac, v7
    v_cvt_pk_bf16_f32 v6, v7, v7
    v_lshlrev_b32 v7, 16, v6
    v_sqrt_f32 v7, v7
    s_nop 0
    v_cvt_pk_bf16_f32 v6, v7, v7
    v_lshlrev_b32 v7, 16, v6
    v_rcp_f32 v8, v7
    v_lshlrev_b32 v10, 16, v36
    v_and_b32 v11, 0xffff0000, v36
    v_sub_f32 v10, v10, v5
    v_sub_f32 v11, v11, v5
    v_cvt_pk_bf16_f32 v6, v10, v11
    v_lshlrev_b32 v10, 16, v6
    v_and_b32 v11, 0xffff0000, v6
    v_mul_f32 v12, v10, v8
    v_fma_f32 v13, -v12, v7, v10
    v_fma_f32 v12, v13, v8, v12
    v_cvt_pk_bf16_f32 v20, v12, v12
    v_mul_f32 v12, v11, v8
    v_fma_f32 v13, -v12, v7, v11
    v_fma_f32 v12, v13, v8, v12
    v_cvt_pk_bf16_f32 v21, v12, v12
    v_lshlrev_b32 v10, 16, v37
    v_and_b32 v11, 0xffff0000, v37
    v_sub_f32 v10, v10, v5
    v_sub_f32 v11, v11, v5
    v_cvt_pk_bf16_f32 v6, v10, v11
    v_lshlrev_b32 v10, 16, v6
    v_and_b32 v11, 0xffff0000, v6
    v_mul_f32 v12, v10, v8
    v_fma_f32 v13, -v12, v7, v10
    v_fma_f32 v12, v13, v8, v12
    v_cvt_pk_bf16_f32 v22, v12, v12
    v_mul_f32 v12, v11, v8
    v_fma_f32 v13, -v12, v7, v11
    v_fma_f32 v12, v13, v8, v12
    v_cvt_pk_bf16_f32 v23, v12, v12
    v_lshlrev_b32 v10, 16, v38
    v_and_b32 v11, 0xffff0000, v38
    v_sub_f32 v10, v10, v5
    v_sub_f32 v11, v11, v5
    v_cvt_pk_bf16_f32 v6, v10, v11
    v_lshlrev_b32 v10, 16, v6
    v_and_b32 v11, 0xffff0000, v6
    v_mul_f32 v12, v10, v8
    v_fma_f32 v13, -v12, v7, v10
    v_fma_f32 v12, v13, v8, v12
    v_cvt_pk_bf16_f32 v24, v12, v12
    v_mul_f32 v12, v11, v8
    v_fma_f32 v13, -v12, v7, v11
    v_fma_f32 v12, v13, v8, v12
    v_cvt_pk_bf16_f32 v25, v12, v12
    v_lshlrev_b32 v10, 16, v39
    v_and_b32 v11, 0xffff0000, v39
    v_sub_f32 v10, v10, v5
    v_sub_f32 v11, v11, v5
    v_cvt_pk_bf16_f32 v6, v10, v11
    v_lshlrev_b32 v10, 16, v6
    v_and_b32 v11, 0xffff0000, v6
    v_mul_f32 v12, v10, v8
    v_fma_f32 v13, -v12, v7, v10
    v_fma_f32 v12, v13, v8, v12
    v_cvt_pk_bf16_f32 v26, v12, v12
    v_mul_f32 v12, v11, v8
    v_fma_f32 v13, -v12, v7, v11
    v_fma_f32 v12, v13, v8, v12
    v_cvt_pk_bf16_f32 v27, v12, v12
    v_lshlrev_b32 v10, 16, v40
    v_and_b32 v11, 0xffff0000, v40
    v_sub_f32 v10, v10, v5
    v_sub_f32 v11, v11, v5
    v_cvt_pk_bf16_f32 v6, v10, v11
    v_lshlrev_b32 v10, 16, v6
    v_and_b32 v11, 0xffff0000, v6
    v_mul_f32 v12, v10, v8
    v_fma_f32 v13, -v12, v7, v10
    v_fma_f32 v12, v13, v8, v12
    v_cvt_pk_bf16_f32 v28, v12, v12
    v_mul_f32 v12, v11, v8
    v_fma_f32 v13, -v12, v7, v11
    v_fma_f32 v12, v13, v8, v12
    v_cvt_pk_bf16_f32 v29, v12, v12
    v_perm_b32 v36, v20, v20, v32
    v_perm_b32 v37, v20, v20, v33
    v_perm_b32 v38, v20, v20, v34
    v_perm_b32 v39, v20, v20, v35
    s_waitcnt vmcnt(20)
    s_nop 0
    v_mfma_f32_16x16x32_bf16 v[10:13], v[36:39], v[44:47], 0
    s_waitcnt vmcnt(19)
    v_mfma_f32_16x16x32_bf16 v[14:17], v[36:39], v[84:87], 0
    v_perm_b32 v36, v21, v21, v32
    v_perm_b32 v37, v21, v21, v33
    v_perm_b32 v38, v21, v21, v34
    v_perm_b32 v39, v21, v21, v35
    s_waitcnt vmcnt(18)
    s_nop 0
    v_mfma_f32_16x16x32_bf16 v[10:13], v[36:39], v[48:51], v[10:13]
    s_waitcnt vmcnt(17)
    v_mfma_f32_16x16x32_bf16 v[14:17], v[36:39], v[88:91], v[14:17]
    v_perm_b32 v36, v22, v22, v32
    v_perm_b32 v37, v22, v22, v33
    v_perm_b32 v38, v22, v22, v34
    v_perm_b32 v39, v22, v22, v35
    s_waitcnt vmcnt(16)
    s_nop 0
    v_mfma_f32_16x16x32_bf16 v[10:13], v[36:39], v[52:55], v[10:13]
    s_waitcnt vmcnt(15)
    v_mfma_f32_16x16x32_bf16 v[14:17], v[36:39], v[92:95], v[14:17]
    v_perm_b32 v36, v23, v23, v32
    v_perm_b32 v37, v23, v23, v33
    v_perm_b32 v38, v23, v23, v34
    v_perm_b32 v39, v23, v23, v35
    s_waitcnt vmcnt(14)
    s_nop 0
    v_mfma_f32_16x16x32_bf16 v[10:13], v[36:39], v[56:59], v[10:13]
    s_waitcnt vmcnt(13)
    v_mfma_f32_16x16x32_bf16 v[14:17], v[36:39], v[96:99], v[14:17]
    v_perm_b32 v36, v24, v24, v32
    v_perm_b32 v37, v24, v24, v33
    v_perm_b32 v38, v24, v24, v34
    v_perm_b32 v39, v24, v24, v35
    s_waitcnt vmcnt(12)
    s_nop 0
    v_mfma_f32_16x16x32_bf16 v[10:13], v[36:39], v[60:63], v[10:13]
    s_waitcnt vmcnt(11)
    v_mfma_f32_16x16x32_bf16 v[14:17], v[36:39], v[100:103], v[14:17]
    v_perm_b32 v36, v25, v25, v32
    v_perm_b32 v37, v25, v25, v33
    v_perm_b32 v38, v25, v25, v34
    v_perm_b32 v39, v25, v25, v35
    s_waitcnt vmcnt(10)
    s_nop 0
    v_mfma_f32_16x16x32_bf16 v[10:13], v[36:39], v[64:67], v[10:13]
    s_waitcnt vmcnt(9)
    v_mfma_f32_16x16x32_bf16 v[14:17], v[36:39], v[104:107], v[14:17]
    v_perm_b32 v36, v26, v26, v32
    v_perm_b32 v37, v26, v26, v33
    v_perm_b32 v38, v26, v26, v34
    v_perm_b32 v39, v26, v26, v35
    s_waitcnt vmcnt(8)
    s_nop 0
    v_mfma_f32_16x16x32_bf16 v[10:13], v[36:39], v[68:71], v[10:13]
    s_waitcnt vmcnt(7)
    v_mfma_f32_16x16x32_bf16 v[14:17], v[36:39], v[108:111], v[14:17]
    v_perm_b32 v36, v27, v27, v32
    v_perm_b32 v37, v27, v27, v33
    v_perm_b32 v38, v27, v27, v34
    v_perm_b32 v39, v27, v27, v35
    s_waitcnt vmcnt(6)
    s_nop 0
    v_mfma_f32_16x16x32_bf16 v[10:13], v[36:39], v[72:75], v[10:13]
    s_waitcnt vmcnt(5)
    v_mfma_f32_16x16x32_bf16 v[14:17], v[36:39], v[112:115], v[14:17]
    v_perm_b32 v36, v28, v28, v32
    v_perm_b32 v37, v28, v28, v33
    v_perm_b32 v38, v28, v28, v34
    v_perm_b32 v39, v28, v28, v35
    s_waitcnt vmcnt(4)
    s_nop 0
    v_mfma_f32_16x16x32_bf16 v[10:13], v[36:39], v[76:79], v[10:13]
    s_waitcnt vmcnt(3)
    v_mfma_f32_16x16x32_bf16 v[14:17], v[36:39], v[116:119], v[14:17]
    v_perm_b32 v36, v29, v29, v32
    v_perm_b32 v37, v29, v29, v33
    v_perm_b32 v38, v29, v29, v34
    v_perm_b32 v39, v29, v29, v35
    s_waitcnt vmcnt(2)
    s_nop 0
    v_mfma_f32_16x16x32_bf16 v[10:13], v[36:39], v[80:83], v[10:13]
    s_waitcnt vmcnt(1)
    v_mfma_f32_16x16x32_bf16 v[14:17], v[36:39], v[120:123], v[14:17]
    v_lshlrev_b32 v40, 6, v43
    v_and_b32 v6, 1, v42
    v_lshl_add_u32 v40, v6, 5, v40
    v_lshrrev_b32 v6, 1, v42
    v_lshl_add_u32 v40, v6, 4, v40
    s_mul_i32 s10, s6, 768
    s_add_u32 s10, s10, 32768
    v_add_u32 v40, s10, v40
    s_lshl_b32 s7, s6, 4
    v_writelane_b32 v40, s7, 12
    s_mov_b32 s10, 229376
    s_mov_b32 s11, 1277952
    s_mov_b32 s78, 0
    s_mov_b32 s79, -1
    v_cndmask_b32 v60, v10, v12, s[78:79]
    v_cndmask_b32 v61, v14, v16, s[78:79]
    v_cndmask_b32 v62, v11, v13, s[78:79]
    v_cndmask_b32 v63, v15, v17, s[78:79]
    v_writelane_b32 v60, s66, 12
    v_writelane_b32 v61, s66, 12
    v_writelane_b32 v62, s66, 12
    v_writelane_b32 v63, s66, 12
    s_mov_b32 s78, 0x0fff1fff
    s_mov_b32 s79, 0x0fff0fff
.Lfl_f:
    s_waitcnt vmcnt(0)
    v_readfirstlane_b32 s81, v19
    s_cmp_lg_u32 s81, 0
    s_nop 2
    s_cbranch_scc1 .Lfl_f_ok
    s_sleep 2
    buffer_load_dword v19, v18, s[60:63], 0 offen sc1
    s_add_u32 s80, s80, 1
    s_cmp_lt_u32 s80, 200000
    s_cbranch_scc1 .Lfl_f
    s_branch .Lend
.Lfl_f_ok:
    s_mov_b32 s80, 0
    s_lshr_b32 s61, s81, 8
    s_lshr_b32 s62, s81, 16
    s_lshr_b32 s63, s81, 24
    v_bfi_b32 v60, v31, s81, v60
    v_bfi_b32 v61, v31, s61, v61
    v_bfi_b32 v62, v31, s62, v62
    v_bfi_b32 v63, v31, s63, v63
    s_mov_b64 exec, s[78:79]
    buffer_store_dwordx4 v[60:63], v40, s[56:59], s10 offen
    s_mov_b64 exec, -1
.Lffn_down:
    s_mul_i32 s7, s4, 61440
    s_mul_i32 s8, s5, 160
    s_add_u32 s7, s7, s8
    s_add_u32 s52, s32, s7
    s_addc_u32 s53, s33, 0
    s_mov_b32 s54, 60320
    s_mov_b32 s55, 0x20000
    v_mul_u32_u24 v5, 15360, v42
    v_lshl_add_u32 v5, v43, 4, v5
    v_cmp_gt_u32 vcc, 10, v43
    v_mov_b32 v6, 0x7ffffff0
    s_nop 0
    v_cndmask_b32 v5, v6, v5, vcc
    s_mov_b32 s7, 0
    buffer_load_dwordx4 v[120:123], v5, s[52:55], s7 offen nt
    s_add_u32 s7, s7, 1280
    buffer_load_dwordx4 v[124:127], v5, s[52:55], s7 offen nt
    s_add_u32 s7, s7, 1280
    buffer_load_dwordx4 v[128:131], v5, s[52:55], s7 offen nt
    s_add_u32 s7, s7, 1280
    buffer_load_dwordx4 v[132:135], v5, s[52:55], s7 offen nt
    s_add_u32 s7, s7, 1280
    buffer_load_dwordx4 v[136:139], v5, s[52:55], s7 offen nt
    s_add_u32 s7, s7, 1280
    buffer_load_dwordx4 v[140:143], v5, s[52:55], s7 offen nt
    s_add_u32 s7, s7, 1280
    buffer_load_dwordx4 v[144:147], v5, s[52:55], s7 offen nt
    s_add_u32 s7, s7, 1280
    buffer_load_dwordx4 v[148:151], v5, s[52:55], s7 offen nt
    s_add_u32 s7, s7, 1280
    buffer_load_dwordx4 v[152:155], v5, s[52:55], s7 offen nt
    s_add_u32 s7, s7, 1280
    buffer_load_dwordx4 v[156:159], v5, s[52:55], s7 offen nt
    s_add_u32 s7, s7, 1280
    buffer_load_dwordx4 v[160:163], v5, s[52:55], s7 offen nt
    s_add_u32 s7, s7, 1280
    buffer_load_dwordx4 v[164:167], v5, s[52:55], s7 offen nt
    s_mul_i32 s8, s69, 12288
    s_and_b32 s7, s4, 1
    s_mul_i32 s7, s7, 384
    s_add_u32 s8, s8, s7
    s_add_u32 s8, s8, 262144
    s_add_u32 s73, s8, 3072
    s_add_u32 s74, s8, 6144
    s_add_u32 s75, s8, 9216
    s_lshl_b32 s9, s69, 8
    s_add_u32 s9, s9, 229376
    v_and_b32 v9, 31, v0
    v_min_u32 v9, 23, v9
    v_lshrrev_b32 v6, 5, v0
    v_mul_u32_u24 v5, 768, v6
    v_lshl_add_u32 v5, v9, 4, v5
    v_lshlrev_b32 v41, 4, v43
    s_sleep 60
.Lgg:
    buffer_load_dwordx4 v[68:71], v5, s[56:59], s8 offen offset:0 sc1
    buffer_load_dwordx4 v[72:75], v5, s[56:59], s8 offen offset:1536 sc1
    buffer_load_dwordx4 v[76:79], v5, s[56:59], s73 offen offset:0 sc1
    buffer_load_dwordx4 v[80:83], v5, s[56:59], s73 offen offset:1536 sc1
    buffer_load_dwordx4 v[84:87], v5, s[56:59], s74 offen offset:0 sc1
    buffer_load_dwordx4 v[88:91], v5, s[56:59], s74 offen offset:1536 sc1
    buffer_load_dwordx4 v[92:95], v5, s[56:59], s75 offen offset:0 sc1
    buffer_load_dwordx4 v[96:99], v5, s[56:59], s75 offen offset:1536 sc1
    s_mov_b64 exec, 0xffff
    buffer_load_dwordx4 v[100:103], v41, s[56:59], s9 offen sc1
    s_waitcnt vmcnt(0)
    v_xor_b32 v6, s81, v100
    v_bitop3_b32 v6, v6, v101, s61 bitop3:0xf6
    v_bitop3_b32 v6, v6, v102, s62 bitop3:0xf6
    v_bitop3_b32 v6, v6, v103, s63 bitop3:0xf6
    v_and_b32 v6, v31, v6
    v_cmp_ne_u32 vcc, 0, v6
    s_cbranch_vccz .Lgg_id
    s_mov_b64 exec, -1
    s_branch .Lgg_re
.Lgg_id:
    s_mov_b64 exec, -1
    v_xor_b32 v6, s81, v68
    v_bitop3_b32 v6, v6, v69, s61 bitop3:0xf6
    v_bitop3_b32 v6, v6, v70, s62 bitop3:0xf6
    v_bitop3_b32 v6, v6, v71, s63 bitop3:0xf6
    v_bitop3_b32 v6, v6, v72, s81 bitop3:0xf6
    v_bitop3_b32 v6, v6, v73, s61 bitop3:0xf6
    v_bitop3_b32 v6, v6, v74, s62 bitop3:0xf6
    v_bitop3_b32 v6, v6, v75, s63 bitop3:0xf6
    v_bitop3_b32 v6, v6, v76, s81 bitop3:0xf6
    v_bitop3_b32 v6, v6, v77, s61 bitop3:0xf6
    v_bitop3_b32 v6, v6, v78, s62 bitop3:0xf6
    v_bitop3_b32 v6, v6, v79, s63 bitop3:0xf6
    v_bitop3_b32 v6, v6, v80, s81 bitop3:0xf6
    v_bitop3_b32 v6, v6, v81, s61 bitop3:0xf6
    v_bitop3_b32 v6, v6, v82, s62 bitop3:0xf6
    v_bitop3_b32 v6, v6, v83, s63 bitop3:0xf6
    v_bitop3_b32 v6, v6, v84, s81 bitop3:0xf6
    v_bitop3_b32 v6, v6, v85, s61 bitop3:0xf6
    v_bitop3_b32 v6, v6, v86, s62 bitop3:0xf6
    v_bitop3_b32 v6, v6, v87, s63 bitop3:0xf6
    v_bitop3_b32 v6, v6, v88, s81 bitop3:0xf6
    v_bitop3_b32 v6, v6, v89, s61 bitop3:0xf6
    v_bitop3_b32 v6, v6, v90, s62 bitop3:0xf6
    v_bitop3_b32 v6, v6, v91, s63 bitop3:0xf6
    v_bitop3_b32 v6, v6, v92, s81 bitop3:0xf6
    v_bitop3_b32 v6, v6, v93, s61 bitop3:0xf6
    v_bitop3_b32 v6, v6, v94, s62 bitop3:0xf6
    v_bitop3_b32 v6, v6, v95, s63 bitop3:0xf6
    v_bitop3_b32 v6, v6, v96, s81 bitop3:0xf6
    v_bitop3_b32 v6, v6, v97, s61 bitop3:0xf6
    v_bitop3_b32 v6, v6, v98, s62 bitop3:0xf6
    v_bitop3_b32 v6, v6, v99, s63 bitop3:0xf6
    v_and_b32 v6, v31, v6
    v_cmp_ne_u32 vcc, 0, v6
    s_cbranch_vccz .Lgg_ok
.Lgg_re:
    s_sleep 16
    s_add_u32 s80, s80, 1
    s_cmp_lt_u32 s80, 6
    s_cbranch_scc1 .Lgg
    s_cmp_lg_u32 s82, 0
    s_cbranch_scc1 .Lfb_f
    s_mov_b64 exec, s[78:79]
    buffer_store_dwordx4 v[60:63], v40, s[56:59], s11 offen sc1
    s_mov_b64 exec, -1
    s_mov_b32 s82, 1
.Lfb_f:
    v_xor_b32 v5, 0x100000, v5
    v_xor_b32 v41, 0x100000, v41
    s_cmp_lt_u32 s80, 200000
    s_cbranch_scc1 .Lgg
    s_branch .Lend
.Lgg_ok:
    s_mov_b64 exec, 0xffff
    s_mov_b32 s80, 0
    s_mov_b32 s83, 0
    v_lshrrev_b32 v6, 8, v100
    v_cmp_ne_u32 vcc, s65, v6
    s_nop 0
    s_cbranch_vccz .Lxc_f
    s_mov_b32 s83, 0x100000
    s_cmp_lg_u32 s82, 0
    s_cbranch_scc1 .Lxc_f
    s_mov_b64 exec, s[78:79]
    buffer_store_dwordx4 v[60:63], v40, s[56:59], s11 offen sc1
    s_mov_b64 exec, -1
.Lxc_f:
    s_mov_b64 exec, -1
    v_and_b32 v68, 0xffffff00, v68
    v_and_b32 v69, 0xffffff00, v69
    v_and_b32 v70, 0xffffff00, v70
    v_and_b32 v71, 0xffffff00, v71
    v_and_b32 v72, 0xffffff00, v72
    v_and_b32 v73, 0xffffff00, v73
    v_and_b32 v74, 0xffffff00, v74
    v_and_b32 v75, 0xffffff00, v75
    v_and_b32 v76, 0xffffff00, v76
    v_and_b32 v77, 0xffffff00, v77
    v_and_b32 v78, 0xffffff00, v78
    v_and_b32 v79, 0xffffff00, v79
    v_and_b32 v80, 0xffffff00, v80
    v_and_b32 v81, 0xffffff00, v81
    v_and_b32 v82, 0xffffff00, v82
    v_and_b32 v83, 0xffffff00, v83
    v_and_b32 v84, 0xffffff00, v84
    v_and_b32 v85, 0xffffff00, v85
    v_and_b32 v86, 0xffffff00, v86
    v_and_b32 v87, 0xffffff00, v87
    v_and_b32 v88, 0xffffff00, v88
    v_and_b32 v89, 0xffffff00, v89
    v_and_b32 v90, 0xffffff00, v90
    v_and_b32 v91, 0xffffff00, v91
    v_and_b32 v92, 0xffffff00, v92
    v_and_b32 v93, 0xffffff00, v93
    v_and_b32 v94, 0xffffff00, v94
    v_and_b32 v95, 0xffffff00, v95
    v_and_b32 v96, 0xffffff00, v96
    v_and_b32 v97, 0xffffff00, v97
    v_and_b32 v98, 0xffffff00, v98
    v_and_b32 v99, 0xffffff00, v99
    v_add_f32 v68, v68, v72
    v_add_f32 v69, v69, v73
    v_add_f32 v70, v70, v74
    v_add_f32 v71, v71, v75
    v_add_f32 v68, v68, v76
    v_add_f32 v69, v69, v77
    v_add_f32 v70, v70, v78
    v_add_f32 v71, v71, v79
    v_add_f32 v68, v68, v80
    v_add_f32 v69, v69, v81
    v_add_f32 v70, v70, v82
    v_add_f32 v71, v71, v83
    v_add_f32 v68, v68, v84
    v_add_f32 v69, v69, v85
    v_add_f32 v70, v70, v86
    v_add_f32 v71, v71, v87
    v_add_f32 v68, v68, v88
    v_add_f32 v69, v69, v89
    v_add_f32 v70, v70, v90
    v_add_f32 v71, v71, v91
    v_add_f32 v68, v68, v92
    v_add_f32 v69, v69, v93
    v_add_f32 v70, v70, v94
    v_add_f32 v71, v71, v95
    v_add_f32 v68, v68, v96
    v_add_f32 v69, v69, v97
    v_add_f32 v70, v70, v98
    v_add_f32 v71, v71, v99
    v_mov_b32 v72, v68
    v_mov_b32 v73, v69
    v_mov_b32 v74, v70
    v_mov_b32 v75, v71
    v_permlane32_swap_b32 v68, v72
    v_permlane32_swap_b32 v69, v73
    v_permlane32_swap_b32 v70, v74
    v_permlane32_swap_b32 v71, v75
    v_add_f32 v68, v68, v72
    v_add_f32 v69, v69, v73
    v_add_f32 v70, v70, v74
    v_add_f32 v71, v71, v75
    v_cvt_pk_bf16_f32 v72, v68, v69
    v_cvt_pk_bf16_f32 v73, v70, v71
    v_lshlrev_b32 v68, 16, v72
    v_and_b32 v69, 0xffff0000, v72
    v_lshlrev_b32 v70, 16, v73
    v_and_b32 v71, 0xffff0000, v73
    v_mul_f32 v68, v68, v69
    v_mul_f32 v70, v70, v71
    v_cvt_pk_bf16_f32 v6, v68, v70
    v_lshlrev_b32 v5, 2, v9
    ds_write_b32 v5, v6 offset:480
    v_mul_u32_u24 v5, 24, v42
    s_waitcnt lgkmcnt(0)
    ds_read_b64 v[70:71], v5 offset:480
    ds_read_b64 v[72:73], v5 offset:488
    ds_read_b64 v[74:75], v5 offset:496
    s_waitcnt lgkmcnt(0)
    v_and_b32 v6, 0xffff, v70
    v_perm_b32 v36, v6, v6, v32
    v_perm_b32 v37, v6, v6, v33
    v_perm_b32 v38, v6, v6, v34
    v_perm_b32 v39, v6, v6, v35
    s_nop 1
    v_mfma_f32_16x16x32_bf16 v[10:13], v[36:39], v[120:123], 0
    v_lshrrev_b32 v6, 16, v70
    v_perm_b32 v36, v6, v6, v32
    v_perm_b32 v37, v6, v6, v33
    v_perm_b32 v38, v6, v6, v34
    v_perm_b32 v39, v6, v6, v35
    s_nop 1
    v_mfma_f32_16x16x32_bf16 v[10:13], v[36:39], v[124:127], v[10:13]
    v_and_b32 v6, 0xffff, v71
    v_perm_b32 v36, v6, v6, v32
    v_perm_b32 v37, v6, v6, v33
    v_perm_b32 v38, v6, v6, v34
    v_perm_b32 v39, v6, v6, v35
    s_nop 1
    v_mfma_f32_16x16x32_bf16 v[10:13], v[36:39], v[128:131], v[10:13]
    v_lshrrev_b32 v6, 16, v71
    v_perm_b32 v36, v6, v6, v32
    v_perm_b32 v37, v6, v6, v33
    v_perm_b32 v38, v6, v6, v34
    v_perm_b32 v39, v6, v6, v35
    s_nop 1
    v_mfma_f32_16x16x32_bf16 v[10:13], v[36:39], v[132:135], v[10:13]
    v_and_b32 v6, 0xffff, v72
    v_perm_b32 v36, v6, v6, v32
    v_perm_b32 v37, v6, v6, v33
    v_perm_b32 v38, v6, v6, v34
    v_perm_b32 v39, v6, v6, v35
    s_nop 1
    v_mfma_f32_16x16x32_bf16 v[10:13], v[36:39], v[136:139], v[10:13]
    v_lshrrev_b32 v6, 16, v72
    v_perm_b32 v36, v6, v6, v32
    v_perm_b32 v37, v6, v6, v33
    v_perm_b32 v38, v6, v6, v34
    v_perm_b32 v39, v6, v6, v35
    s_nop 1
    v_mfma_f32_16x16x32_bf16 v[10:13], v[36:39], v[140:143], v[10:13]
    v_and_b32 v6, 0xffff, v73
    v_perm_b32 v36, v6, v6, v32
    v_perm_b32 v37, v6, v6, v33
    v_perm_b32 v38, v6, v6, v34
    v_perm_b32 v39, v6, v6, v35
    s_nop 1
    v_mfma_f32_16x16x32_bf16 v[10:13], v[36:39], v[144:147], v[10:13]
    v_lshrrev_b32 v6, 16, v73
    v_perm_b32 v36, v6, v6, v32
    v_perm_b32 v37, v6, v6, v33
    v_perm_b32 v38, v6, v6, v34
    v_perm_b32 v39, v6, v6, v35
    s_nop 1
    v_mfma_f32_16x16x32_bf16 v[10:13], v[36:39], v[148:151], v[10:13]
    v_and_b32 v6, 0xffff, v74
    v_perm_b32 v36, v6, v6, v32
    v_perm_b32 v37, v6, v6, v33
    v_perm_b32 v38, v6, v6, v34
    v_perm_b32 v39, v6, v6, v35
    s_nop 1
    v_mfma_f32_16x16x32_bf16 v[10:13], v[36:39], v[152:155], v[10:13]
    v_lshrrev_b32 v6, 16, v74
    v_perm_b32 v36, v6, v6, v32
    v_perm_b32 v37, v6, v6, v33
    v_perm_b32 v38, v6, v6, v34
    v_perm_b32 v39, v6, v6, v35
    s_nop 1
    v_mfma_f32_16x16x32_bf16 v[10:13], v[36:39], v[156:159], v[10:13]
    v_and_b32 v6, 0xffff, v75
    v_perm_b32 v36, v6, v6, v32
    v_perm_b32 v37, v6, v6, v33
    v_perm_b32 v38, v6, v6, v34
    v_perm_b32 v39, v6, v6, v35
    s_nop 1
    v_mfma_f32_16x16x32_bf16 v[10:13], v[36:39], v[160:163], v[10:13]
    v_lshrrev_b32 v6, 16, v75
    v_perm_b32 v36, v6, v6, v32
    v_perm_b32 v37, v6, v6, v33
    v_perm_b32 v38, v6, v6, v34
    v_perm_b32 v39, v6, v6, v35
    s_nop 1
    v_mfma_f32_16x16x32_bf16 v[10:13], v[36:39], v[164:167], v[10:13]
    v_lshlrev_b32 v5, 10, v43
    v_lshl_add_u32 v5, v42, 4, v5
    s_mul_i32 s8, s5, 10240
    s_lshl_b32 s7, s4, 5
    s_add_u32 s8, s8, s7
    s_add_u32 s8, s8, 2097152
    s_nop 1
    v_bfi_b32 v10, v31, s81, v10
    v_bfi_b32 v11, v31, s61, v11
    v_bfi_b32 v12, v31, s62, v12
    v_bfi_b32 v13, v31, s63, v13
    s_mov_b64 exec, 0x03ff03ff
    buffer_store_dwordx4 v[10:13], v5, s[56:59], s8 offen sc1
    s_endpgm
.Lkv:
    s_and_b32 s7, s2, 7
    s_lshr_b32 s8, s2, 3
    s_lshr_b32 s9, s8, 3
    s_lshl_b32 s4, s7, 2
    s_add_u32 s4, s4, s9
    s_and_b32 s5, s8, 7
    s_lshl_b32 s6, s4, 3
    s_add_u32 s6, s6, s5
    s_mov_b32 s80, 0
    s_mov_b32 s67, 0x3fb8aa3b
    v_mov_b32 v18, 0
    v_mov_b32 v31, 0xff
    v_lshrrev_b32 v2, 3, v0
    v_and_b32 v4, 7, v0
    v_lshlrev_b32 v4, 4, v4
    s_sub_u32 s64, s3, 4
    v_mul_u32_u24 v3, 384, v2
    v_add_u32 v3, v3, v4
    s_mul_i32 s7, s4, 3145728
    s_mul_i32 s8, s5, 98304
    s_add_u32 s7, s7, s8
    s_mul_i32 s8, s64, 12288
    s_add_u32 s7, s7, s8
    s_add_u32 s7, s7, 2359296
    s_mul_i32 s8, s64, 0
    s_mul_i32 s9, s5, 1
    s_add_u32 s8, s8, s9
    s_add_u32 s9, s8, 0
    s_and_b32 s9, s9, 3
    s_mul_i32 s74, s9, 3072
    s_add_u32 s9, s8, 1
    s_and_b32 s9, s9, 3
    s_mul_i32 s75, s9, 3072
    s_add_u32 s9, s8, 2
    s_and_b32 s9, s9, 3
    s_mul_i32 s76, s9, 3072
    s_add_u32 s9, s8, 3
    s_and_b32 s9, s9, 3
    s_mul_i32 s77, s9, 3072
    s_cmp_lg_u32 s3, 11
    s_cbranch_scc1 .Lnoinit
    v_min_u32 v5, 20, v0
    v_lshlrev_b32 v5, 2, v5
    v_mov_b32 v6, -1
    ds_write_b32 v5, v6 offset:384
.Lnoinit:
    s_waitcnt lgkmcnt(0)
    s_add_u32 s40, s18, s7
    s_addc_u32 s41, s19, 0
    s_mov_b32 s42, 12288
    s_mov_b32 s43, 0x20000
    buffer_load_dwordx4 v[40:43], v3, s[40:43], s74 offen offset:0 nt
    buffer_load_dwordx4 v[44:47], v3, s[40:43], s74 offen offset:128 nt
    s_barrier
    buffer_load_dwordx4 v[48:51], v3, s[40:43], s74 offen offset:256 nt
    s_add_u32 s44, s20, s7
    s_addc_u32 s45, s21, 0
    s_mov_b32 s46, 12288
    s_mov_b32 s47, 0x20000
    s_mov_b32 s56, s38
    s_mov_b32 s57, s39
    s_mov_b32 s58, 2359296
    s_mov_b32 s59, 0x20000
    v_and_b32 v1, 15, v0
    v_lshrrev_b32 v2, 4, v0
    v_mul_u32_u24 v6, 7680, v2
    v_lshl_add_u32 v6, v1, 4, v6
    v_cmp_gt_u32 vcc, 10, v1
    v_mov_b32 v7, 0x7ffffff0
    s_nop 0
    v_cndmask_b32 v6, v7, v6, vcc
    s_mul_i32 s7, s4, 245760
    s_mul_i32 s8, s64, 30720
    s_add_u32 s7, s7, s8
    s_mul_i32 s8, s5, 160
    s_add_u32 s7, s7, s8
    s_add_u32 s48, s24, s7
    s_addc_u32 s49, s25, 0
    s_mov_b32 s50, 29600
    s_mov_b32 s51, 0x20000
    s_movk_i32 s66, 3840
    v_bfe_u32 v7, v0, 3, 1
    v_mul_u32_u24 v7, 0x202, v7
    v_add_u32 v7, 0x100, v7
    v_and_b32 v8, 1, v0
    v_lshlrev_b32 v8, 4, v8
    v_lshlrev_b32 v7, v8, v7
    v_mov_b32 v9, 0x0c0c0000
    v_lshrrev_b32 v9, v8, v9
    v_or_b32 v7, v7, v9
    v_bfe_u32 v8, v0, 1, 2
    v_mov_b32 v9, 0x0c0c0c0c
    v_cmp_eq_u32 vcc, 0, v8
    s_nop 1
    v_cndmask_b32 v32, v9, v7, vcc
    v_cmp_eq_u32 vcc, 1, v8
    s_nop 1
    v_cndmask_b32 v33, v9, v7, vcc
    v_cmp_eq_u32 vcc, 2, v8
    s_nop 1
    v_cndmask_b32 v34, v9, v7, vcc
    v_cmp_eq_u32 vcc, 3, v8
    s_nop 1
    v_cndmask_b32 v35, v9, v7, vcc
    v_lshrrev_b32 v16, 5, v0
    v_mul_u32_u24 v16, 768, v16
    v_lshl_add_u32 v16, v4, 1, v16
    v_and_b32 v13, 1, v2
    v_lshl_add_u32 v16, v13, 4, v16
    s_mul_i32 s7, s64, 1536
    v_add_u32 v16, s7, v16
    s_lshl_b32 s7, s64, 2
    v_mov_b32 v17, s7
    v_lshlrev_b32 v14, 4, v0
    s_lshl_b32 s69, s4, 13
    s_lshl_b32 s7, s64, 10
    s_add_u32 s69, s69, s7
    s_add_u32 s69, s69, 524288
    v_lshlrev_b32 v19, 5, v1
    v_lshl_add_u32 v19, v2, 4, v19
    s_mul_i32 s7, s64, 384
    v_add_u32 v19, s7, v19
    s_mov_b32 s78, 0x00ff00ff
    s_mov_b32 s79, 0xff00ff00
    s_mov_b32 s70, 0x3d93cd3a
    s_waitcnt vmcnt(2)
    buffer_load_dwordx4 v[52:55], v3, s[40:43], s75 offen offset:0 nt
    s_waitcnt vmcnt(2)
    buffer_load_dwordx4 v[56:59], v3, s[40:43], s75 offen offset:128 nt
    s_waitcnt vmcnt(2)
    buffer_load_dwordx4 v[60:63], v3, s[40:43], s75 offen offset:256 nt
    s_waitcnt vmcnt(2)
    buffer_load_dwordx4 v[64:67], v3, s[40:43], s76 offen offset:0 nt
    s_waitcnt vmcnt(2)
    buffer_load_dwordx4 v[68:71], v3, s[40:43], s76 offen offset:128 nt
    s_waitcnt vmcnt(2)
    buffer_load_dwordx4 v[72:75], v3, s[40:43], s76 offen offset:256 nt
    s_waitcnt vmcnt(2)
    buffer_load_dwordx4 v[76:79], v3, s[40:43], s77 offen offset:0 nt
    s_waitcnt vmcnt(2)
    buffer_load_dwordx4 v[80:83], v3, s[40:43], s77 offen offset:128 nt
    s_waitcnt vmcnt(2)
    buffer_load_dwordx4 v[84:87], v3, s[40:43], s77 offen offset:256 nt
    s_waitcnt vmcnt(2)
    buffer_load_dwordx4 v[88:91], v3, s[44:47], s74 offen offset:0 nt
    s_waitcnt vmcnt(2)
    buffer_load_dwordx4 v[92:95], v3, s[44:47], s74 offen offset:128 nt
    s_waitcnt vmcnt(2)
    buffer_load_dwordx4 v[96:99], v3, s[44:47], s74 offen offset:256 nt
    s_waitcnt vmcnt(2)
    buffer_load_dwordx4 v[100:103], v3, s[44:47], s75 offen offset:0 nt
    s_waitcnt vmcnt(2)
    buffer_load_dwordx4 v[104:107], v3, s[44:47], s75 offen offset:128 nt
    s_waitcnt vmcnt(2)
    buffer_load_dwordx4 v[108:111], v3, s[44:47], s75 offen offset:256 nt
.Lqs:
    ds_read_b128 v[36:39], v18 offset:448
    ds_read_b128 v[160:163], v4 offset:0
    ds_read_b128 v[164:167], v4 offset:128
    ds_read_b128 v[20:23], v4 offset:256
    s_waitcnt lgkmcnt(0)
    v_max3_u32 v13, v36, v37, v38
    v_cmp_eq_u32 vcc, -1, v13
    s_nop 0
    s_cbranch_vccz .Lqs_ok
    s_sleep 2
    s_add_u32 s80, s80, 1
    s_cmp_lt_u32 s80, 2000000
    s_cbranch_scc1 .Lqs
    s_branch .Lend
.Lqs_ok:
    s_mov_b32 s80, 0
    v_readfirstlane_b32 s81, v36
    v_add_u32 v14, v14, v39
    v_dot2_f32_bf16 v8, v40, v160, 0
    v_dot2_f32_bf16 v9, v52, v160, 0
    v_dot2_f32_bf16 v10, v64, v160, 0
    v_dot2_f32_bf16 v11, v76, v160, 0
    v_dot2_f32_bf16 v8, v41, v161, v8
    v_dot2_f32_bf16 v9, v53, v161, v9
    v_dot2_f32_bf16 v10, v65, v161, v10
    v_dot2_f32_bf16 v11, v77, v161, v11
    v_dot2_f32_bf16 v8, v42, v162, v8
    v_dot2_f32_bf16 v9, v54, v162, v9
    v_dot2_f32_bf16 v10, v66, v162, v10
    v_dot2_f32_bf16 v11, v78, v162, v11
    v_dot2_f32_bf16 v8, v43, v163, v8
    v_dot2_f32_bf16 v9, v55, v163, v9
    v_dot2_f32_bf16 v10, v67, v163, v10
    v_dot2_f32_bf16 v11, v79, v163, v11
    v_dot2_f32_bf16 v8, v44, v164, v8
    v_dot2_f32_bf16 v9, v56, v164, v9
    v_dot2_f32_bf16 v10, v68, v164, v10
    v_dot2_f32_bf16 v11, v80, v164, v11
    v_dot2_f32_bf16 v8, v45, v165, v8
    v_dot2_f32_bf16 v9, v57, v165, v9
    v_dot2_f32_bf16 v10, v69, v165, v10
    v_dot2_f32_bf16 v11, v81, v165, v11
    v_dot2_f32_bf16 v8, v46, v166, v8
    v_dot2_f32_bf16 v9, v58, v166, v9
    v_dot2_f32_bf16 v10, v70, v166, v10
    v_dot2_f32_bf16 v11, v82, v166, v11
    v_dot2_f32_bf16 v8, v47, v167, v8
    v_dot2_f32_bf16 v9, v59, v167, v9
    v_dot2_f32_bf16 v10, v71, v167, v10
    v_dot2_f32_bf16 v11, v83, v167, v11
    v_dot2_f32_bf16 v8, v48, v20, v8
    v_dot2_f32_bf16 v9, v60, v20, v9
    v_dot2_f32_bf16 v10, v72, v20, v10
    v_dot2_f32_bf16 v11, v84, v20, v11
    v_dot2_f32_bf16 v8, v49, v21, v8
    v_dot2_f32_bf16 v9, v61, v21, v9
    v_dot2_f32_bf16 v10, v73, v21, v10
    v_dot2_f32_bf16 v11, v85, v21, v11
    v_dot2_f32_bf16 v8, v50, v22, v8
    v_dot2_f32_bf16 v9, v62, v22, v9
    v_dot2_f32_bf16 v10, v74, v22, v10
    v_dot2_f32_bf16 v11, v86, v22, v11
    v_dot2_f32_bf16 v8, v51, v23, v8
    v_dot2_f32_bf16 v9, v63, v23, v9
    v_dot2_f32_bf16 v10, v75, v23, v10
    v_dot2_f32_bf16 v11, v87, v23, v11
    s_lshr_b32 s61, s81, 8
    s_lshr_b32 s62, s81, 16
    s_lshr_b32 s63, s81, 24
    s_waitcnt vmcnt(2)
    buffer_load_dwordx4 v[112:115], v3, s[44:47], s76 offen offset:0 nt
    v_add_f32_dpp v8, v8, v8 quad_perm:[1,0,3,2] row_mask:0xf bank_mask:0xf
    v_add_f32_dpp v9, v9, v9 quad_perm:[1,0,3,2] row_mask:0xf bank_mask:0xf
    v_add_f32_dpp v10, v10, v10 quad_perm:[1,0,3,2] row_mask:0xf bank_mask:0xf
    v_add_f32_dpp v11, v11, v11 quad_perm:[1,0,3,2] row_mask:0xf bank_mask:0xf
    v_add_f32_dpp v8, v8, v8 quad_perm:[2,3,0,1] row_mask:0xf bank_mask:0xf
    v_add_f32_dpp v9, v9, v9 quad_perm:[2,3,0,1] row_mask:0xf bank_mask:0xf
    v_add_f32_dpp v10, v10, v10 quad_perm:[2,3,0,1] row_mask:0xf bank_mask:0xf
    v_add_f32_dpp v11, v11, v11 quad_perm:[2,3,0,1] row_mask:0xf bank_mask:0xf
    v_add_f32_dpp v8, v8, v8 row_half_mirror row_mask:0xf bank_mask:0xf
    v_add_f32_dpp v9, v9, v9 row_half_mirror row_mask:0xf bank_mask:0xf
    v_add_f32_dpp v10, v10, v10 row_half_mirror row_mask:0xf bank_mask:0xf
    v_add_f32_dpp v11, v11, v11 row_half_mirror row_mask:0xf bank_mask:0xf
    v_cvt_pk_bf16_f32 v36, v8, v9
    v_cvt_pk_bf16_f32 v37, v10, v11
    v_lshlrev_b32 v8, 16, v36
    v_and_b32 v9, 0xffff0000, v36
    v_lshlrev_b32 v10, 16, v37
    v_and_b32 v11, 0xffff0000, v37
    v_mul_f32 v8, s70, v8
    v_mul_f32 v9, s70, v9
    v_mul_f32 v10, s70, v10
    v_mul_f32 v11, s70, v11
    v_cvt_pk_bf16_f32 v36, v8, v9
    v_cvt_pk_bf16_f32 v37, v10, v11
    v_lshlrev_b32 v8, 16, v36
    v_and_b32 v9, 0xffff0000, v36
    v_lshlrev_b32 v10, 16, v37
    v_and_b32 v11, 0xffff0000, v37
    v_max3_f32 v12, v8, v9, v10
    v_max_f32 v12, v12, v11
    s_nop 1
    v_max_f32_dpp v12, v12, v12 row_ror:8 row_mask:0xf bank_mask:0xf
    s_nop 0
    v_readlane_b32 s12, v12, 0
    v_readlane_b32 s13, v12, 16
    v_readlane_b32 s14, v12, 32
    v_readlane_b32 s15, v12, 48
    v_mov_b32 v12, s12
    v_max_f32 v12, s13, v12
    v_max_f32 v12, s14, v12
    v_max_f32 v12, s15, v12
    v_min_u32 v13, -2, v12
    ds_write_b32 v17, v13 offset:384
    s_waitcnt vmcnt(2)
    buffer_load_dwordx4 v[116:119], v3, s[44:47], s76 offen offset:128 nt
    v_sub_f32 v8, v8, v12
    v_sub_f32 v9, v9, v12
    v_sub_f32 v10, v10, v12
    v_sub_f32 v11, v11, v12
    v_mul_f32 v8, s67, v8
    v_mul_f32 v9, s67, v9
    v_mul_f32 v10, s67, v10
    v_mul_f32 v11, s67, v11
    v_exp_f32 v8, v8
    v_exp_f32 v9, v9
    v_exp_f32 v10, v10
    v_exp_f32 v11, v11
    v_add_f32 v13, v8, v9
    v_add_f32 v13, v13, v10
    v_add_f32 v13, v13, v11
    v_cvt_pk_bf16_f32 v36, v8, v8
    v_cvt_pk_bf16_f32 v37, v9, v9
    v_cvt_pk_bf16_f32 v38, v10, v10
    v_cvt_pk_bf16_f32 v39, v11, v11
    v_add_f32_dpp v13, v13, v13 row_ror:8 row_mask:0xf bank_mask:0xf
    s_nop 0
    v_readlane_b32 s12, v13, 0
    v_readlane_b32 s13, v13, 16
    v_readlane_b32 s14, v13, 32
    v_readlane_b32 s15, v13, 48
    v_mov_b32 v13, s12
    v_add_f32 v13, s13, v13
    v_add_f32 v13, s14, v13
    v_add_f32 v13, s15, v13
    v_min_u32 v13, -2, v13
    ds_write_b32 v17, v13 offset:416
    v_perm_b32 v40, v36, v36, v32
    v_perm_b32 v41, v36, v36, v33
    v_perm_b32 v42, v36, v36, v34
    v_perm_b32 v43, v36, v36, v35
    v_perm_b32 v44, v37, v37, v32
    v_perm_b32 v45, v37, v37, v33
    v_perm_b32 v46, v37, v37, v34
    v_perm_b32 v47, v37, v37, v35
    v_perm_b32 v48, v38, v38, v32
    v_perm_b32 v49, v38, v38, v33
    v_perm_b32 v50, v38, v38, v34
    v_perm_b32 v51, v38, v38, v35
    v_perm_b32 v52, v39, v39, v32
    v_perm_b32 v53, v39, v39, v33
    v_perm_b32 v54, v39, v39, v34
    v_perm_b32 v55, v39, v39, v35
    s_waitcnt vmcnt(2)
    buffer_load_dwordx4 v[120:123], v3, s[44:47], s76 offen offset:256 nt
    v_mfma_f32_16x16x32_bf16 v[56:59], v[40:43], v[88:91], 0
    v_mfma_f32_16x16x32_bf16 v[60:63], v[40:43], v[92:95], 0
    v_mfma_f32_16x16x32_bf16 v[64:67], v[40:43], v[96:99], 0
    v_mfma_f32_16x16x32_bf16 v[56:59], v[44:47], v[100:103], v[56:59]
    v_mfma_f32_16x16x32_bf16 v[60:63], v[44:47], v[104:107], v[60:63]
    v_mfma_f32_16x16x32_bf16 v[64:67], v[44:47], v[108:111], v[64:67]
    s_waitcnt vmcnt(2)
    buffer_load_dwordx4 v[124:127], v3, s[44:47], s77 offen offset:0 nt
    v_mfma_f32_16x16x32_bf16 v[56:59], v[48:51], v[112:115], v[56:59]
    s_waitcnt vmcnt(2)
    buffer_load_dwordx4 v[128:131], v3, s[44:47], s77 offen offset:128 nt
    v_mfma_f32_16x16x32_bf16 v[60:63], v[48:51], v[116:119], v[60:63]
    s_waitcnt vmcnt(2)
    buffer_load_dwordx4 v[132:135], v3, s[44:47], s77 offen offset:256 nt
    v_mfma_f32_16x16x32_bf16 v[64:67], v[48:51], v[120:123], v[64:67]
    s_waitcnt vmcnt(2)
    buffer_load_dwordx4 v[136:139], v6, s[48:51], 0 offen offset:0 nt
    buffer_load_dwordx4 v[140:143], v6, s[48:51], 0 offen offset:1280 nt
    buffer_load_dwordx4 v[144:147], v6, s[48:51], 0 offen offset:2560 nt
    buffer_load_dwordx4 v[148:151], v6, s[48:51], s66 offen offset:0 nt
    buffer_load_dwordx4 v[152:155], v6, s[48:51], s66 offen offset:1280 nt
    buffer_load_dwordx4 v[156:159], v6, s[48:51], s66 offen offset:2560 nt
    s_waitcnt vmcnt(8)
    v_mfma_f32_16x16x32_bf16 v[56:59], v[52:55], v[124:127], v[56:59]
    s_waitcnt vmcnt(7)
    v_mfma_f32_16x16x32_bf16 v[60:63], v[52:55], v[128:131], v[60:63]
    s_waitcnt vmcnt(6)
    v_mfma_f32_16x16x32_bf16 v[64:67], v[52:55], v[132:135], v[64:67]
    s_mov_b64 exec, s[78:79]
    s_nop 2
    ds_write_b128 v16, v[56:59] offset:1024
    s_nop 0
    ds_write_b128 v16, v[60:63] offset:1280
    s_nop 0
    ds_write_b128 v16, v[64:67] offset:1536
    s_mov_b64 exec, -1
    s_waitcnt lgkmcnt(0)
    s_barrier
    s_sleep 6
.Log:
    buffer_load_dwordx3 v[64:66], v14, s[56:59], s69 offen sc1
    s_waitcnt vmcnt(0)
    v_xor_b32 v72, s81, v64
    v_bitop3_b32 v72, v72, v65, s61 bitop3:0xf6
    v_bitop3_b32 v72, v72, v66, s62 bitop3:0xf6
    v_and_b32 v72, v31, v72
    v_cmp_ne_u32 vcc, 0, v72
    s_cbranch_vccz .Log_ok
    s_add_u32 s80, s80, 1
    s_cmp_lt_u32 s80, 200000
    s_cbranch_scc1 .Log
    s_branch .Lend
.Log_ok:
    v_and_b32 v76, 0xffffff00, v64
    v_and_b32 v77, 0xffffff00, v65
    v_and_b32 v78, 0xffffff00, v66
.Log_c:
    v_add_f32_dpp v76, v76, v76 quad_perm:[1,0,3,2] row_mask:0xf bank_mask:0xf
    v_add_f32_dpp v77, v77, v77 quad_perm:[1,0,3,2] row_mask:0xf bank_mask:0xf
    v_add_f32_dpp v78, v78, v78 quad_perm:[1,0,3,2] row_mask:0xf bank_mask:0xf
    v_add_f32_dpp v76, v76, v76 quad_perm:[2,3,0,1] row_mask:0xf bank_mask:0xf
    v_add_f32_dpp v77, v77, v77 quad_perm:[2,3,0,1] row_mask:0xf bank_mask:0xf
    v_add_f32_dpp v78, v78, v78 quad_perm:[2,3,0,1] row_mask:0xf bank_mask:0xf
    v_add_f32_dpp v76, v76, v76 row_half_mirror row_mask:0xf bank_mask:0xf
    v_add_f32_dpp v77, v77, v77 row_half_mirror row_mask:0xf bank_mask:0xf
    v_add_f32_dpp v78, v78, v78 row_half_mirror row_mask:0xf bank_mask:0xf
    v_cvt_pk_bf16_f32 v76, v76, 0
    v_cvt_pk_bf16_f32 v77, v77, 0
    v_cvt_pk_bf16_f32 v78, v78, 0
    v_perm_b32 v88, v76, v76, v32
    v_perm_b32 v89, v76, v76, v33
    v_perm_b32 v90, v76, v76, v34
    v_perm_b32 v91, v76, v76, v35
    v_mov_b32_dpp v80, v76 row_ror:8 row_mask:0xf bank_mask:0xf
    v_mov_b32_dpp v81, v77 row_ror:8 row_mask:0xf bank_mask:0xf
    v_mov_b32_dpp v82, v78 row_ror:8 row_mask:0xf bank_mask:0xf
    v_perm_b32 v92, v77, v77, v32
    v_perm_b32 v93, v77, v77, v33
    v_perm_b32 v94, v77, v77, v34
    v_perm_b32 v95, v77, v77, v35
    v_mfma_f32_16x16x32_bf16 v[72:75], v[88:91], v[136:139], 0
    v_perm_b32 v96, v78, v78, v32
    v_perm_b32 v97, v78, v78, v33
    v_perm_b32 v98, v78, v78, v34
    v_perm_b32 v99, v78, v78, v35
    v_mfma_f32_16x16x32_bf16 v[72:75], v[92:95], v[140:143], v[72:75]
    v_perm_b32 v100, v80, v80, v32
    v_perm_b32 v101, v80, v80, v33
    v_perm_b32 v102, v80, v80, v34
    v_perm_b32 v103, v80, v80, v35
    v_mfma_f32_16x16x32_bf16 v[72:75], v[96:99], v[144:147], v[72:75]
    v_perm_b32 v104, v81, v81, v32
    v_perm_b32 v105, v81, v81, v33
    v_perm_b32 v106, v81, v81, v34
    v_perm_b32 v107, v81, v81, v35
    v_mfma_f32_16x16x32_bf16 v[72:75], v[100:103], v[148:151], v[72:75]
    v_perm_b32 v108, v82, v82, v32
    v_perm_b32 v109, v82, v82, v33
    v_perm_b32 v110, v82, v82, v34
    v_perm_b32 v111, v82, v82, v35
    v_mfma_f32_16x16x32_bf16 v[72:75], v[104:107], v[152:155], v[72:75]
    s_nop 0
    v_mfma_f32_16x16x32_bf16 v[72:75], v[108:111], v[156:159], v[72:75]
    s_mov_b64 exec, 0x03ff03ff
    s_nop 6
    ds_write_b128 v19, v[72:75] offset:13312
    s_waitcnt lgkmcnt(0)
    s_barrier
.Lend:
    s_endpgm
.section .rodata,"a"
.p2align 6
.amdhsa_kernel recurrent_scan__sliding_block_cached__glu_gated_bilinear__decode_kernel
  .amdhsa_next_free_vgpr 168
  .amdhsa_next_free_sgpr 102
  .amdhsa_accum_offset 168
  .amdhsa_group_segment_fixed_size 0
  .amdhsa_kernarg_size 96
  .amdhsa_user_sgpr_count 2
  .amdhsa_user_sgpr_kernarg_segment_ptr 1
  .amdhsa_system_sgpr_workgroup_id_x 1
  .amdhsa_float_denorm_mode_32 3
.end_amdhsa_kernel
```
